```python
import torch

def _softmax(x, axis=-1):
    return torch.softmax(x, dim=axis)
def _gelu(x):
    return torch.nn.functional.gelu(x, approximate="tanh")
def _silu(x):
    return torch.nn.functional.silu(x)
def _sigmoid(x):
    return torch.sigmoid(x)
def _layernorm(x, axis=-1, eps=1e-5):
    m = x.mean(dim=axis, keepdim=True)
    v = x.var(dim=axis, keepdim=True, unbiased=False)
    return (x - m) / torch.sqrt(v + eps)
def _scatter_add(tgt, idx, src, axis=0):
    return tgt.clone().index_add_(axis, idx, src)
def _segment_sum(src, seg, n):
    out = torch.zeros((n,) + src.shape[1:], dtype=src.dtype)
    return out.index_add_(0, seg, src)
def _pad(x, pw):
    flat = tuple(v for pair in reversed(pw) for v in pair)
    return torch.nn.functional.pad(x, flat)

kernel_name = 'standalone__edge_featured_mpnn_egc__graph'

def setup_inputs():

    _w = (lambda a: (lambda t: t.to(torch.bfloat16) if t.is_floating_point() else t)(torch.as_tensor(a)))
    N, deg, D, De = 10000, 32, 128, max(4, 1)
    E = N * deg
    return {
        "x": _w((lambda *s: torch.randn(*s, dtype=torch.bfloat16) * 0.1)(N, D)),
        "e_attr": _w((lambda *s: torch.randn(*s, dtype=torch.bfloat16) * 0.1)(E, De)),
        "src": _w((lambda lo, hi, *s: torch.randint(lo, hi, s))(0, N, E).to(torch.int64)),
        "dst": _w((lambda lo, hi, *s: torch.randint(lo, hi, s))(0, N, E).to(torch.int64)),
        "u_w": _w((lambda *s: torch.randn(*s, dtype=torch.bfloat16) * 0.05)(D, D)),
        "v_w": _w((lambda *s: torch.randn(*s, dtype=torch.bfloat16) * 0.05)(D, D)),
        "g_w": _w((lambda *s: torch.randn(*s, dtype=torch.bfloat16) * 0.1)(2 * D + De, D)),
    }

def reference(x, e_attr, src, dst, u_w, v_w, g_w):
    N, D = x.shape
    g_in = torch.concatenate([x[dst], x[src], e_attr], axis=-1)
    eta = _sigmoid(g_in @ g_w)
    hv = x @ v_w
    msg = eta * hv[src]
    agg = _segment_sum(msg, dst, N)
    return _silu(x @ u_w + agg)
```

```asm
; @launch grid=(256,1,1) block=(768,1,1) lds=162816
.amdgcn_target "amdgcn-amd-amdhsa--gfx950"
.text
.globl standalone__edge_featured_mpnn_egc__graph_kernel
.p2align 8
.type standalone__edge_featured_mpnn_egc__graph_kernel,@function
standalone__edge_featured_mpnn_egc__graph_kernel:
    s_load_dwordx16 s[4:19], s[0:1], 0
    s_load_dwordx2 s[20:21], s[0:1], 72
    s_getpc_b64 s[28:29]
L_pc:
    v_lshlrev_b32 v3, 7, v0
    v_cmp_gt_u32 vcc, L_codeend-L_pc-64, v3
    s_cbranch_vccz L_nopf
    s_mov_b64 exec, vcc
    global_load_dword v164, v3, s[28:29]
    s_mov_b64 exec, -1
L_nopf:
    v_lshrrev_b32 v2, 6, v0
    v_and_b32 v1, 63, v0
    v_readfirstlane_b32 s3, v2
    s_bfe_u32 s22, s2, 0x10002
    s_and_b32 s30, s2, 3
    s_mul_i32 s30, s30, 31
    s_lshr_b32 s31, s2, 3
    s_add_u32 s23, s30, s31
    s_cmp_eq_u32 s30, 93
    s_subb_u32 s31, s31, 0
    s_cmp_ge_i32 s31, 31
    s_cbranch_scc1 L_end
    s_lshl_b32 s24, s23, 1
    s_add_u32 s24, s24, s22
    s_mov_b32 s25, 0
L_restart:
    s_cmp_ge_u32 s3, 4
    s_cbranch_scc1 L_nosort
    v_mov_b32 v48, 0
    v_mov_b32 v49, 0
    v_mov_b32 v50, 0
    v_mov_b32 v51, 0
    v_lshlrev_b32 v10, 4, v1
    ds_write_b128 v10, v[48:51] offset:1024
    s_mul_i32 s30, s24, 5120
    v_lshl_add_u32 v3, v0, 4, s30
    s_add_u32 s30, s30, 4096
    v_lshl_add_u32 v18, v0, 2, s30
    v_lshlrev_b32 v10, 1, v3
    v_lshlrev_b32 v11, 1, v18
    v_mov_b32 v17, 10223616
    s_waitcnt lgkmcnt(0)
    global_load_dwordx4 v[4:7], v3, s[10:11]
    global_load_dword v8, v18, s[10:11]
    s_add_u32 s28, s20, 10223616
    s_addc_u32 s29, s21, 0
    s_load_dword s65, s[28:29], 0
    s_barrier
    s_barrier
    s_branch L_sort
L_nosort:
    s_and_b32 s32, s3, 3
    s_lshr_b32 s33, s3, 3
    v_lshrrev_b32 v2, 4, v1
    v_and_b32 v4, 15, v1
    s_lshl_b32 s30, s32, 2
    v_add_u32 v6, s30, v2
    v_xor_b32 v7, v4, v6
    v_lshlrev_b32 v7, 4, v7
    v_lshl_add_u32 v7, v6, 8, v7
    s_mul_i32 s73, s23, 20480
    s_mul_i32 s31, s33, 12288
    s_add_u32 s30, s73, s31
    v_add_u32 v7, s30, v7
    v_add_u32 v8, 0x1000, v7
    v_add_u32 v9, 0x2000, v7
    s_lshl_b32 s30, s32, 10
    s_add_u32 s31, s31, s30
    s_add_u32 m0, s31, 108544
    v_subrev_u32 v30, 256, v0
    v_lshlrev_b32 v31, 4, v30
    v_mov_b32 v36, 0
    v_mov_b32 v37, 0
    v_mov_b32 v38, 0
    v_mov_b32 v39, 0
    v_add_u32 v40, 32032, v31
    ds_write_b128 v40, v[36:39]
    ds_write_b128 v40, v[36:39] offset:8192
    s_lshr_b32 s30, s2, 3
    s_lshl_b32 s30, s30, 2
    v_add_u32 v3, s30, v1
    v_and_b32 v3, 127, v3
    s_lshl_b32 s30, s22, 7
    s_cmp_eq_u32 s3, 4
    s_cselect_b32 s31, 0x8000, 0
    s_add_u32 s30, s30, s31
    v_lshl_add_u32 v3, v3, 8, s30
    s_waitcnt lgkmcnt(0)
    s_cmp_lg_u32 s33, 0
    s_cbranch_scc1 L_nowpf
    s_cmp_eq_u32 s3, 5
    s_cselect_b32 s34, s14, s16
    s_cselect_b32 s35, s15, s17
    s_cmp_eq_u32 s3, 7
    s_cselect_b32 s34, s12, s34
    s_cselect_b32 s35, s13, s35
    s_mov_b64 exec, 0xffff
    global_load_dword v167, v3, s[34:35]
    s_mov_b64 exec, -1
L_nowpf:
    s_waitcnt lgkmcnt(0)
    s_barrier
    s_mov_b32 s29, m0
    v_lshrrev_b32 v5, 3, v1
    v_and_b32 v3, 1, v2
    s_and_b32 s30, s3, 1
    s_lshl_b32 s30, s30, 1
    v_or_b32 v3, s30, v3
    v_lshlrev_b32 v3, 1, v3
    v_and_b32 v20, 7, v1
    v_xor_b32 v3, v3, v20
    v_lshlrev_b32 v3, 4, v3
    v_lshl_add_u32 v10, v5, 8, v3
    s_sub_u32 s28, s3, 4
    s_lshl_b32 s30, s28, 11
    s_lshl_b32 s31, s22, 7
    s_add_u32 s30, s30, s31
    v_add_u32 v10, s30, v10
    v_add_u32 v11, 0x4000, v10
    s_lshl_b32 s28, s28, 10
    s_add_u32 s34, s16, 32768
    s_addc_u32 s35, s17, 0
    s_cmp_lg_u32 s3, 11
    s_cbranch_scc1 L_noc
    v_and_b32 v5, 3, v5
    v_lshlrev_b32 v20, 4, v20
    v_lshl_add_u32 v5, v5, 8, v20
    s_add_u32 s31, s31, 65536
    s_mov_b32 m0, 161792
    v_add_u32 v5, s31, v5
    global_load_lds_dwordx4 v5, s[16:17]
L_noc:
    s_add_u32 m0, s28, 75776
    s_nop 0
    global_load_lds_dwordx4 v10, s[34:35]
    s_add_u32 m0, m0, 0x2000
    s_nop 0
    global_load_lds_dwordx4 v11, s[34:35]
    s_add_u32 m0, m0, 0x2000
    s_nop 0
    global_load_lds_dwordx4 v10, s[14:15]
    s_add_u32 m0, m0, 0x2000
    s_nop 0
    global_load_lds_dwordx4 v11, s[14:15]
    s_mov_b32 m0, s29
    v_lshl_add_u32 v5, v1, 7, s73
    v_add_u32 v3, 8192, v5
    v_add_u32 v20, 12288, v5
    s_barrier
    s_cmp_lg_u32 s3, 4
    s_cbranch_scc1 L_noxpf
    global_load_dword v166, v20, s[4:5]
    global_load_dword v165, v5, s[4:5]
    s_mov_b32 exec_hi, 0
    global_load_dword v164, v3, s[4:5]
    s_mov_b32 exec_hi, -1
L_noxpf:
    global_load_lds_dwordx4 v7, s[4:5]
    s_add_u32 m0, m0, 0x1000
    s_cmp_lg_u32 s33, 0
    global_load_lds_dwordx4 v8, s[4:5]
    s_cbranch_scc1 L_x2
    s_add_u32 m0, m0, 0x1000
    s_nop 0
    global_load_lds_dwordx4 v9, s[4:5]
L_x2:
    v_mov_b32 v7, 0x1000000
    s_mov_b64 exec, 1
    ds_add_u32 v36, v7 offset:1536
    s_mov_b64 exec, -1
    v_mov_b32 v32, 2147483392
    v_mov_b32 v33, v32
    v_mov_b32 v34, v32
    v_mov_b32 v35, v32
    ds_write_b128 v40, v[36:39] offset:16384
    ds_write_b128 v40, v[36:39] offset:24576
    ds_write_b128 v40, v[36:39] offset:32768
    ds_write_b128 v40, v[36:39] offset:35392
    ds_write_b128 v31, v[32:35] offset:10240
    ds_write_b128 v31, v[32:35] offset:18432
    ds_write_b128 v31, v[32:35] offset:23840
    v_and_b32 v32, 3, v30
    v_bfe_u32 v33, v30, 3, 3
    v_lshrrev_b32 v34, 5, v30
    s_and_b32 s30, s3, 3
    s_add_u32 s30, s30, 16
    s_cmp_ge_u32 s3, 8
    s_cselect_b32 s31, 7, 3
    s_cselect_b32 s29, 0, 6
    s_cselect_b64 vcc, -1, 0
    v_and_b32 v33, s31, v33
    v_mov_b32 v35, s30
    v_cndmask_b32 v34, v34, v35, vcc
    v_lshl_add_u32 v32, v34, 2, v32
    v_bfe_u32 v34, v30, 2, 1
    v_mul_u32_u24 v35, 376, v34
    v_mul_u32_u24 v41, 65536, v34
    v_mul_u32_u24 v42, 31488, v34
    v_lshlrev_b32 v43, 4, v34
    v_add_u32 v35, 272, v35
    v_add_u32 v41, 10240, v41
    v_sub_u32 v42, 32000, v42
    v_sub_u32 v43, 16, v43
    v_lshlrev_b32 v33, 2, v33
    v_mad_u32_u24 v41, v32, v35, v41
    v_mad_u32_u24 v41, v33, v43, v41
    v_lshlrev_b32 v35, 5, v35
    v_lshlrev_b32 v34, 3, v43
    v_sub_u32 v35, v35, v34
    v_cmp_gt_u32 s[48:49], 8, v33
    v_and_b32 v33, 7, v33
    v_add_u32 v34, 2, v33
    v_cmp_gt_u32 s[52:53], s29, v33
    v_cmp_gt_u32 s[54:55], s29, v34
    v_cndmask_b32 v44, v35, 0, s[48:49]
    v_cndmask_b32 v46, v35, 0, s[48:49]
    v_add_u32 v44, v41, v44
    v_lshl_add_u32 v46, v43, 1, v46
    v_add_u32 v46, v41, v46
    v_add_u32 v45, v44, v43
    v_add_u32 v47, v46, v43
    v_cndmask_b32 v44, v42, v44, s[52:53]
    v_cndmask_b32 v45, v42, v45, s[52:53]
    v_cndmask_b32 v46, v42, v46, s[54:55]
    v_cndmask_b32 v47, v42, v47, s[54:55]
    ds_write_b128 v31, v[44:47] offset:2048
    s_cmp_ge_u32 s3, 6
    s_cbranch_scc1 L_pf3
    v_mul_u32_u24 v42, 272, v30
    v_add_u32 v42, 10240, v42
    v_lshlrev_b32 v41, 2, v30
    ds_write_b32 v41, v42 offset:0
L_pf3:
    v_bfe_u32 v3, v1, 2, 2
    v_lshl_add_u32 v5, v2, 3, v3
    v_lshrrev_b32 v3, 1, v3
    v_and_b32 v6, 1, v2
    v_lshl_or_b32 v3, v6, 1, v3
    v_xor_b32 v3, s32, v3
    v_lshlrev_b32 v3, 5, v3
    v_lshl_add_u32 v10, v5, 7, v3
    v_and_b32 v3, 3, v1
    v_lshl_add_u32 v10, v3, 3, v10
    s_mul_i32 s31, s33, 53248
    s_add_u32 s31, s31, 75776
    v_add_u32 v10, s31, v10
    v_xor_b32 v3, v2, v4
    v_lshlrev_b32 v3, 4, v3
    v_lshl_add_u32 v12, v4, 8, v3
    v_add_u32 v12, 108544, v12
    v_xor_b32 v13, 64, v12
    v_xor_b32 v14, 0x80, v12
    v_xor_b32 v15, 0xc0, v12
    s_mul_i32 s30, s22, 2560000
    s_add_u32 s30, s30, s73
    s_lshl_b32 s31, s32, 6
    s_add_u32 s30, s30, s31
    v_lshlrev_b32 v11, 10, v2
    v_lshl_add_u32 v11, v4, 2, v11
    v_add_u32 v11, s30, v11
    s_lshl_b32 s31, s32, 5
    s_add_u32 s31, s31, 75776
    v_mul_u32_u24 v16, 648, v4
    v_lshl_add_u32 v16, v2, 3, v16
    v_add_u32 v16, s31, v16
    s_mov_b32 s40, 0xbfb8aa3b
    s_mov_b32 s42, 0x4f800000
    s_mov_b32 s44, 0x07060100
    s_mov_b32 s45, 0x07060302
    s_mov_b32 s46, 0x3f80
    v_mov_b32 v17, 0x0d800000
    v_mov_b32 v19, 1
    v_mov_b32 v18, 0
    s_cmp_lg_u32 s25, 0
    s_cbranch_scc1 L_tag_g
    v_mov_b32 v2, 0
    s_mov_b32 s31, 4000000
L_tg_g:
    ds_read_b128 v[160:163], v2 offset:1520
    s_sub_u32 s31, s31, 1
    s_cbranch_scc1 L_tag_g
    s_waitcnt lgkmcnt(0)
    v_readfirstlane_b32 s30, v163
    v_readfirstlane_b32 s47, v161
    s_cmp_lg_u32 s30, 4
    s_cbranch_scc1 L_tg_g
    s_mul_i32 s27, s47, 0x85ebca6b
    s_mul_i32 s26, s47, 0x9e3779b1
    s_add_u32 s27, s27, 0x5bd1e995
    s_add_u32 s26, s26, 0x7f4a7c15
L_tag_g:
    s_waitcnt vmcnt(0)
L_stg:
    s_mov_b64 exec, 1
    ds_add_u32 v18, v19 offset:1536
    s_mov_b64 exec, -1
    v_mov_b32 v2, 0
    s_mov_b32 s31, 4000000
L_w_g1:
L_wf_g1:
    ds_read_b32 v3, v2 offset:1536
    s_sub_u32 s31, s31, 1
    s_cbranch_scc1 L_wd_g1
    s_waitcnt lgkmcnt(0)
    v_readfirstlane_b32 s30, v3
    s_and_b32 s30, s30, 255
    s_cmp_lg_u32 s30, 8
    s_cbranch_scc1 L_w_g1
L_wd_g1:
    s_cmp_lg_u32 s33, 0
    s_cbranch_scc1 L_gemm2
    s_cmp_lg_u32 s25, 0
    s_cbranch_scc1 L_nog1
    s_setprio 2
    ds_read_b128 v[52:55], v12 offset:0
    ds_read_b64_tr_b16 v[20:21], v10 offset:0
    ds_read_b64_tr_b16 v[22:23], v10 offset:512
    ds_read_b64_tr_b16 v[36:37], v10 offset:16384
    ds_read_b64_tr_b16 v[38:39], v10 offset:16896
    ds_read_b128 v[56:59], v13 offset:0
    ds_read_b64_tr_b16 v[24:25], v10 offset:4096
    ds_read_b64_tr_b16 v[26:27], v10 offset:4608
    ds_read_b64_tr_b16 v[40:41], v10 offset:20480
    ds_read_b64_tr_b16 v[42:43], v10 offset:20992
    ds_read_b128 v[60:63], v14 offset:0
    ds_read_b64_tr_b16 v[28:29], v10 offset:8192
    ds_read_b64_tr_b16 v[30:31], v10 offset:8704
    ds_read_b64_tr_b16 v[44:45], v10 offset:24576
    ds_read_b64_tr_b16 v[46:47], v10 offset:25088
    s_waitcnt lgkmcnt(10)
    v_mfma_f32_16x16x32_bf16 v[132:135], v[52:55], v[20:23], 0
    v_mfma_f32_16x16x32_bf16 v[136:139], v[52:55], v[36:39], 0
    ds_read_b128 v[64:67], v15 offset:0
    ds_read_b64_tr_b16 v[32:33], v10 offset:12288
    ds_read_b64_tr_b16 v[34:35], v10 offset:12800
    ds_read_b64_tr_b16 v[48:49], v10 offset:28672
    ds_read_b64_tr_b16 v[50:51], v10 offset:29184
    s_waitcnt lgkmcnt(10)
    v_mfma_f32_16x16x32_bf16 v[132:135], v[56:59], v[24:27], v[132:135]
    v_mfma_f32_16x16x32_bf16 v[136:139], v[56:59], v[40:43], v[136:139]
    ds_read_b128 v[68:71], v12 offset:4096
    ds_read_b128 v[72:75], v13 offset:4096
    ds_read_b128 v[76:79], v14 offset:4096
    ds_read_b128 v[80:83], v15 offset:4096
    s_waitcnt lgkmcnt(9)
    v_mfma_f32_16x16x32_bf16 v[132:135], v[60:63], v[28:31], v[132:135]
    v_mfma_f32_16x16x32_bf16 v[136:139], v[60:63], v[44:47], v[136:139]
    ds_read_b128 v[84:87], v12 offset:8192
    ds_read_b128 v[88:91], v13 offset:8192
    ds_read_b128 v[92:95], v14 offset:8192
    ds_read_b128 v[96:99], v15 offset:8192
    s_waitcnt lgkmcnt(8)
    v_mfma_f32_16x16x32_bf16 v[132:135], v[64:67], v[32:35], v[132:135]
    v_mfma_f32_16x16x32_bf16 v[136:139], v[64:67], v[48:51], v[136:139]
    ds_read_b128 v[100:103], v12 offset:12288
    ds_read_b128 v[104:107], v13 offset:12288
    ds_read_b128 v[108:111], v14 offset:12288
    ds_read_b128 v[112:115], v15 offset:12288
    s_waitcnt lgkmcnt(8)
    v_mfma_f32_16x16x32_bf16 v[140:143], v[68:71], v[20:23], 0
    v_mfma_f32_16x16x32_bf16 v[144:147], v[68:71], v[36:39], 0
    ds_read_b128 v[116:119], v12 offset:16384
    v_mfma_f32_16x16x32_bf16 v[140:143], v[72:75], v[24:27], v[140:143]
    v_mfma_f32_16x16x32_bf16 v[144:147], v[72:75], v[40:43], v[144:147]
    ds_read_b128 v[120:123], v13 offset:16384
    v_mfma_f32_16x16x32_bf16 v[140:143], v[76:79], v[28:31], v[140:143]
    v_mfma_f32_16x16x32_bf16 v[144:147], v[76:79], v[44:47], v[144:147]
    ds_read_b128 v[124:127], v14 offset:16384
    v_mfma_f32_16x16x32_bf16 v[140:143], v[80:83], v[32:35], v[140:143]
    v_mfma_f32_16x16x32_bf16 v[144:147], v[80:83], v[48:51], v[144:147]
    ds_read_b128 v[128:131], v15 offset:16384
    s_mov_b64 exec, 1
    ds_add_u32 v18, v19 offset:1540
    s_mov_b64 exec, -1
    v_mul_f32 v132, s40, v132
    v_mul_f32 v133, s40, v133
    v_mul_f32 v134, s40, v134
    v_mul_f32 v135, s40, v135
    v_fma_f32 v136, v136, s42, v17
    v_fma_f32 v137, v137, s42, v17
    v_fma_f32 v138, v138, s42, v17
    v_fma_f32 v139, v139, s42, v17
    v_cvt_pk_bf16_f32 v4, v132, v133
    v_cvt_pk_bf16_f32 v5, v134, v135
    v_xor_b32 v2, 0x80008000, v4
    v_xor_b32 v3, 0x80008000, v5
    v_sub_u32_sdwa v136, v136, sext(v2) dst_sel:DWORD dst_unused:UNUSED_PAD src0_sel:DWORD src1_sel:WORD_0
    v_sub_u32_sdwa v137, v137, sext(v2) dst_sel:DWORD dst_unused:UNUSED_PAD src0_sel:DWORD src1_sel:WORD_1
    v_sub_u32_sdwa v138, v138, sext(v3) dst_sel:DWORD dst_unused:UNUSED_PAD src0_sel:DWORD src1_sel:WORD_0
    v_sub_u32_sdwa v139, v139, sext(v3) dst_sel:DWORD dst_unused:UNUSED_PAD src0_sel:DWORD src1_sel:WORD_1
    v_perm_b32 v136, v136, v4, s44
    global_store_dword v11, v136, s[20:21] offset:0 sc1
    v_perm_b32 v137, v137, v4, s45
    global_store_dword v11, v137, s[20:21] offset:256 sc1
    v_perm_b32 v138, v138, v5, s44
    global_store_dword v11, v138, s[20:21] offset:512 sc1
    v_perm_b32 v139, v139, v5, s45
    global_store_dword v11, v139, s[20:21] offset:768 sc1
    v_add_u32 v11, 0x1000, v11
    s_waitcnt lgkmcnt(0)
    v_mfma_f32_16x16x32_bf16 v[148:151], v[84:87], v[20:23], 0
    v_mfma_f32_16x16x32_bf16 v[152:155], v[84:87], v[36:39], 0
    v_mfma_f32_16x16x32_bf16 v[148:151], v[88:91], v[24:27], v[148:151]
    v_mfma_f32_16x16x32_bf16 v[152:155], v[88:91], v[40:43], v[152:155]
    v_mfma_f32_16x16x32_bf16 v[148:151], v[92:95], v[28:31], v[148:151]
    v_mfma_f32_16x16x32_bf16 v[152:155], v[92:95], v[44:47], v[152:155]
    v_mfma_f32_16x16x32_bf16 v[148:151], v[96:99], v[32:35], v[148:151]
    v_mfma_f32_16x16x32_bf16 v[152:155], v[96:99], v[48:51], v[152:155]
    v_mul_f32 v140, s40, v140
    v_mul_f32 v141, s40, v141
    v_mul_f32 v142, s40, v142
    v_mul_f32 v143, s40, v143
    v_fma_f32 v144, v144, s42, v17
    v_fma_f32 v145, v145, s42, v17
    v_fma_f32 v146, v146, s42, v17
    v_fma_f32 v147, v147, s42, v17
    v_cvt_pk_bf16_f32 v4, v140, v141
    v_cvt_pk_bf16_f32 v5, v142, v143
    v_xor_b32 v2, 0x80008000, v4
    v_xor_b32 v3, 0x80008000, v5
    v_sub_u32_sdwa v144, v144, sext(v2) dst_sel:DWORD dst_unused:UNUSED_PAD src0_sel:DWORD src1_sel:WORD_0
    v_sub_u32_sdwa v145, v145, sext(v2) dst_sel:DWORD dst_unused:UNUSED_PAD src0_sel:DWORD src1_sel:WORD_1
    v_sub_u32_sdwa v146, v146, sext(v3) dst_sel:DWORD dst_unused:UNUSED_PAD src0_sel:DWORD src1_sel:WORD_0
    v_sub_u32_sdwa v147, v147, sext(v3) dst_sel:DWORD dst_unused:UNUSED_PAD src0_sel:DWORD src1_sel:WORD_1
    v_perm_b32 v144, v144, v4, s44
    global_store_dword v11, v144, s[20:21] offset:0 sc1
    v_perm_b32 v145, v145, v4, s45
    global_store_dword v11, v145, s[20:21] offset:256 sc1
    v_perm_b32 v146, v146, v5, s44
    global_store_dword v11, v146, s[20:21] offset:512 sc1
    v_perm_b32 v147, v147, v5, s45
    global_store_dword v11, v147, s[20:21] offset:768 sc1
    v_add_u32 v11, 0x1000, v11
    v_mfma_f32_16x16x32_bf16 v[132:135], v[100:103], v[20:23], 0
    v_mfma_f32_16x16x32_bf16 v[136:139], v[100:103], v[36:39], 0
    v_mfma_f32_16x16x32_bf16 v[132:135], v[104:107], v[24:27], v[132:135]
    v_mfma_f32_16x16x32_bf16 v[136:139], v[104:107], v[40:43], v[136:139]
    v_mfma_f32_16x16x32_bf16 v[132:135], v[108:111], v[28:31], v[132:135]
    v_mfma_f32_16x16x32_bf16 v[136:139], v[108:111], v[44:47], v[136:139]
    v_mfma_f32_16x16x32_bf16 v[132:135], v[112:115], v[32:35], v[132:135]
    v_mfma_f32_16x16x32_bf16 v[136:139], v[112:115], v[48:51], v[136:139]
    v_mul_f32 v148, s40, v148
    v_mul_f32 v149, s40, v149
    v_mul_f32 v150, s40, v150
    v_mul_f32 v151, s40, v151
    v_fma_f32 v152, v152, s42, v17
    v_fma_f32 v153, v153, s42, v17
    v_fma_f32 v154, v154, s42, v17
    v_fma_f32 v155, v155, s42, v17
    v_cvt_pk_bf16_f32 v4, v148, v149
    v_cvt_pk_bf16_f32 v5, v150, v151
    v_xor_b32 v2, 0x80008000, v4
    v_xor_b32 v3, 0x80008000, v5
    v_sub_u32_sdwa v152, v152, sext(v2) dst_sel:DWORD dst_unused:UNUSED_PAD src0_sel:DWORD src1_sel:WORD_0
    v_sub_u32_sdwa v153, v153, sext(v2) dst_sel:DWORD dst_unused:UNUSED_PAD src0_sel:DWORD src1_sel:WORD_1
    v_sub_u32_sdwa v154, v154, sext(v3) dst_sel:DWORD dst_unused:UNUSED_PAD src0_sel:DWORD src1_sel:WORD_0
    v_sub_u32_sdwa v155, v155, sext(v3) dst_sel:DWORD dst_unused:UNUSED_PAD src0_sel:DWORD src1_sel:WORD_1
    s_waitcnt vmcnt(4)
    v_perm_b32 v152, v152, v4, s44
    global_store_dword v11, v152, s[20:21] offset:0 sc1
    v_perm_b32 v153, v153, v4, s45
    global_store_dword v11, v153, s[20:21] offset:256 sc1
    v_perm_b32 v154, v154, v5, s44
    global_store_dword v11, v154, s[20:21] offset:512 sc1
    v_perm_b32 v155, v155, v5, s45
    global_store_dword v11, v155, s[20:21] offset:768 sc1
    v_add_u32 v11, 0x1000, v11
    v_mfma_f32_16x16x32_bf16 v[140:143], v[116:119], v[20:23], 0
    v_mfma_f32_16x16x32_bf16 v[144:147], v[116:119], v[36:39], 0
    v_mfma_f32_16x16x32_bf16 v[140:143], v[120:123], v[24:27], v[140:143]
    v_mfma_f32_16x16x32_bf16 v[144:147], v[120:123], v[40:43], v[144:147]
    v_mfma_f32_16x16x32_bf16 v[140:143], v[124:127], v[28:31], v[140:143]
    v_mfma_f32_16x16x32_bf16 v[144:147], v[124:127], v[44:47], v[144:147]
    v_mfma_f32_16x16x32_bf16 v[140:143], v[128:131], v[32:35], v[140:143]
    v_mfma_f32_16x16x32_bf16 v[144:147], v[128:131], v[48:51], v[144:147]
    v_mul_f32 v132, s40, v132
    v_mul_f32 v133, s40, v133
    v_mul_f32 v134, s40, v134
    v_mul_f32 v135, s40, v135
    v_fma_f32 v136, v136, s42, v17
    v_fma_f32 v137, v137, s42, v17
    v_fma_f32 v138, v138, s42, v17
    v_fma_f32 v139, v139, s42, v17
    v_cvt_pk_bf16_f32 v4, v132, v133
    v_cvt_pk_bf16_f32 v5, v134, v135
    v_xor_b32 v2, 0x80008000, v4
    v_xor_b32 v3, 0x80008000, v5
    v_sub_u32_sdwa v136, v136, sext(v2) dst_sel:DWORD dst_unused:UNUSED_PAD src0_sel:DWORD src1_sel:WORD_0
    v_sub_u32_sdwa v137, v137, sext(v2) dst_sel:DWORD dst_unused:UNUSED_PAD src0_sel:DWORD src1_sel:WORD_1
    v_sub_u32_sdwa v138, v138, sext(v3) dst_sel:DWORD dst_unused:UNUSED_PAD src0_sel:DWORD src1_sel:WORD_0
    v_sub_u32_sdwa v139, v139, sext(v3) dst_sel:DWORD dst_unused:UNUSED_PAD src0_sel:DWORD src1_sel:WORD_1
    s_waitcnt vmcnt(8)
    v_perm_b32 v136, v136, v4, s44
    global_store_dword v11, v136, s[20:21] offset:0 sc1
    v_perm_b32 v137, v137, v4, s45
    global_store_dword v11, v137, s[20:21] offset:256 sc1
    v_perm_b32 v138, v138, v5, s44
    global_store_dword v11, v138, s[20:21] offset:512 sc1
    v_perm_b32 v139, v139, v5, s45
    global_store_dword v11, v139, s[20:21] offset:768 sc1
    v_add_u32 v11, 0x1000, v11
    v_mul_f32 v140, s40, v140
    v_mul_f32 v141, s40, v141
    v_mul_f32 v142, s40, v142
    v_mul_f32 v143, s40, v143
    v_fma_f32 v144, v144, s42, v17
    v_fma_f32 v145, v145, s42, v17
    v_fma_f32 v146, v146, s42, v17
    v_fma_f32 v147, v147, s42, v17
    v_cvt_pk_bf16_f32 v4, v140, v141
    v_cvt_pk_bf16_f32 v5, v142, v143
    v_xor_b32 v2, 0x80008000, v4
    v_xor_b32 v3, 0x80008000, v5
    v_sub_u32_sdwa v144, v144, sext(v2) dst_sel:DWORD dst_unused:UNUSED_PAD src0_sel:DWORD src1_sel:WORD_0
    v_sub_u32_sdwa v145, v145, sext(v2) dst_sel:DWORD dst_unused:UNUSED_PAD src0_sel:DWORD src1_sel:WORD_1
    v_sub_u32_sdwa v146, v146, sext(v3) dst_sel:DWORD dst_unused:UNUSED_PAD src0_sel:DWORD src1_sel:WORD_0
    v_sub_u32_sdwa v147, v147, sext(v3) dst_sel:DWORD dst_unused:UNUSED_PAD src0_sel:DWORD src1_sel:WORD_1
    s_waitcnt vmcnt(12)
    v_perm_b32 v144, v144, v4, s44
    global_store_dword v11, v144, s[20:21] offset:0 sc1
    v_perm_b32 v145, v145, v4, s45
    global_store_dword v11, v145, s[20:21] offset:256 sc1
    v_perm_b32 v146, v146, v5, s44
    global_store_dword v11, v146, s[20:21] offset:512 sc1
    v_perm_b32 v147, v147, v5, s45
    global_store_dword v11, v147, s[20:21] offset:768 sc1
    s_setprio 0
    v_and_b32 v2, 15, v1
    v_lshrrev_b32 v3, 4, v1
    v_lshl_add_u32 v3, v2, 2, v3
    v_lshlrev_b32 v3, 1, v3
    v_add_u32 v3, 161792, v3
    ds_read_u16 v64, v3
    ds_read_u16 v65, v3 offset:128
    ds_read_u16 v66, v3 offset:256
    ds_read_u16 v67, v3 offset:384
    v_and_b32 v63, 3, v1
    v_lshlrev_b32 v20, 3, v2
    v_lshlrev_b32 v21, 3, v2
    v_lshlrev_b32 v14, 4, v2
    v_lshlrev_b32 v15, 4, v2
    v_mov_b32 v12, 0x8888
    v_bfe_u32 v60, v1, 3, 2
    v_bfe_u32 v61, v1, 2, 1
    v_lshrrev_b32 v62, 5, v1
    v_and_b32 v2, 1, v60
    v_lshlrev_b32 v2, 4, v2
    v_lshlrev_b32 v2, v2, s46
    v_lshrrev_b32 v60, 1, v60
    v_lshl_add_u32 v3, v61, 1, v60
    v_sub_u32 v63, v63, v62
    v_lshl_add_u32 v3, v63, 1, v3
    v_and_b32 v63, 1, v63
    v_lshl_or_b32 v3, v63, 4, v3
    v_xor_b32 v61, v61, v62
    v_lshl_or_b32 v60, v61, 4, v60
    v_cmp_eq_u32 s[48:49], 0, v3
    v_cmp_eq_u32 s[50:51], 1, v3
    v_cmp_eq_u32 s[52:53], 2, v3
    v_cmp_eq_u32 vcc, 3, v3
    v_cndmask_b32 v4, 0, v2, s[48:49]
    v_cndmask_b32 v5, 0, v2, s[50:51]
    v_cndmask_b32 v6, 0, v2, s[52:53]
    v_cndmask_b32 v7, 0, v2, vcc
    v_cmp_eq_u32 s[48:49], 4, v3
    v_cmp_eq_u32 s[50:51], 5, v3
    v_cmp_eq_u32 s[52:53], 6, v3
    v_cmp_eq_u32 vcc, 7, v3
    v_cndmask_b32 v8, 0, v2, s[48:49]
    v_cndmask_b32 v9, 0, v2, s[50:51]
    v_cndmask_b32 v10, 0, v2, s[52:53]
    v_cndmask_b32 v11, 0, v2, vcc
    v_cmp_eq_u32 s[48:49], 0, v60
    v_cmp_eq_u32 s[50:51], 1, v60
    v_and_b32 v63, 3, v1
    v_lshlrev_b32 v61, 3, v63
    v_cndmask_b32 v16, 0, v2, s[48:49]
    v_cndmask_b32 v17, 0, v2, s[50:51]
    v_add_u32 v13, 11552, v61
    s_lshl_b32 s30, s3, 9
    s_sub_u32 s31, s30, 4096
    s_max_i32 s31, s31, 0
    s_add_u32 s30, s30, s31
    s_add_u32 s30, s30, 2048
    v_lshrrev_b32 v2, 4, v1
    v_lshl_add_u32 v22, v2, 4, s30
    v_bfe_u32 v3, v1, 2, 2
    v_lshl_add_u32 v23, v3, 4, s30
    v_lshl_add_u32 v23, v2, 2, v23
    s_lshl_b32 s30, s3, 2
    s_add_u32 s30, s30, 32
    v_add_u32 v2, s30, v2
    v_mul_u32_u24 v68, 648, v2
    v_add_u32 v68, v68, v20
    v_add_u32 v68, 55040, v68
    s_mul_i32 s30, s23, 20480
    s_lshl_b32 s31, s22, 7
    s_add_u32 s30, s30, s31
    v_lshl_add_u32 v69, v2, 8, v20
    v_add_u32 v69, s30, v69
    s_waitcnt lgkmcnt(0)
    v_lshlrev_b32 v60, 16, v64
    v_lshlrev_b32 v61, 16, v65
    v_lshlrev_b32 v62, 16, v66
    v_lshlrev_b32 v63, 16, v67
    v_mul_f32 v60, s40, v60
    v_mul_f32 v61, s40, v61
    v_mul_f32 v62, s40, v62
    v_mul_f32 v63, s40, v63
    v_cvt_pk_bf16_f32 v18, v60, v61
    v_cvt_pk_bf16_f32 v19, v62, v63
    s_lshl_b32 s30, s24, 7
    s_add_u32 s30, s30, 9961472
    v_mov_b32 v60, s30
    v_mov_b32 v62, s26
    v_mov_b32 v63, s27
    v_mov_b32 v2, 0
    v_mov_b32 v3, 1
    s_lshl_b32 s30, s32, 13
    s_lshl_b32 s31, s22, 7
    s_add_u32 s30, s30, s31
    s_add_u32 s30, s30, 9961472
    v_lshl_add_u32 v64, v1, 8, s30
    s_mul_i32 s30, s32, 655360
    s_lshr_b32 s31, s2, 3
    s_mul_i32 s31, s31, 20480
    s_add_u32 s30, s30, s31
    v_lshl_add_u32 v65, v1, 7, s30
    s_mul_i32 s30, s22, 2560000
    v_add_u32 v65, s30, v65
    s_mov_b64 exec, 1
    s_waitcnt vmcnt(0)
    ds_add_rtn_u32 v61, v2, v3 offset:1544
    s_waitcnt lgkmcnt(0)
    v_readfirstlane_b32 s30, v61
    s_cmp_lg_u32 s30, 3
    s_cbranch_scc1 L_nofl
    global_store_dwordx2 v60, v[62:63], s[20:21] sc1
    ds_add_u32 v2, v3 offset:1544
L_nofl:
    s_mov_b64 exec, -1
    v_mov_b32 v2, 0
    s_mov_b32 s31, 4000000
L_w_pg:
L_wf_pg:
    ds_read_b32 v3, v2 offset:1536
    s_sub_u32 s31, s31, 1
    s_cbranch_scc1 L_wd_pg
    s_waitcnt lgkmcnt(0)
    v_readfirstlane_b32 s30, v3
    s_and_b32 s30, s30, 16711680
    s_cmp_lg_u32 s30, 524288
    s_cbranch_scc1 L_w_pg
L_wd_pg:
    s_mov_b32 exec_hi, 0
    s_cmp_eq_u32 s32, 3
    s_cselect_b32 exec_lo, 0x1fffffff, -1
    global_load_dwordx2 v[66:67], v64, s[20:21] sc1
    s_waitcnt vmcnt(0)
    v_cmp_ne_u64 s[66:67], s[26:27], v[66:67]
    s_mov_b32 s73, 0
    s_lshr_b32 s30, s2, 3
    s_bitcmp1_b32 s66, s30
    s_cbranch_scc1 L_nogpe
    s_mov_b32 s73, 1
    s_bitcmp1_b32 exec_lo, s30
    s_cbranch_scc0 L_nogpe
    s_mov_b64 exec, -1
    s_bfm_b64 exec, 40, 0
    global_load_dword v35, v65, s[20:21] sc1
L_nogpe:
    s_cmp_lg_u64 s[66:67], 0
    s_cbranch_scc1 L_p2n
    s_cmp_lg_u32 s73, 0
    s_cbranch_scc1 L_gra
    s_bfm_b64 exec, 32, 0
    global_load_dword v35, v65, s[20:21] sc1
L_gra:
    s_mov_b64 exec, 1
    v_mov_b32 v2, 0
    v_mov_b32 v3, 1
    ds_add_u32 v2, v3 offset:1560
L_p2n:
    s_mov_b64 exec, -1
    s_branch L_b4
L_nog1:
    s_mov_b64 exec, 1
    ds_add_u32 v18, v19 offset:1540
    s_mov_b64 exec, -1
    s_branch L_rec
L_gemm2:
    v_lshrrev_b32 v5, 3, v1
    v_bfe_u32 v3, v1, 4, 1
    v_lshlrev_b32 v3, 1, v3
    v_and_b32 v20, 7, v1
    v_xor_b32 v3, v3, v20
    v_lshlrev_b32 v3, 4, v3
    v_lshl_add_u32 v6, v5, 8, v3
    s_lshl_b32 s30, s22, 7
    s_and_b32 s31, s3, 1
    s_lshl_b32 s31, s31, 14
    s_add_u32 s30, s30, s31
    v_add_u32 v6, s30, v6
    v_xor_b32 v7, 64, v6
    v_add_u32 v8, 2048, v6
    v_add_u32 v9, 3072, v7
    v_add_u32 v7, 1024, v7
    s_lshl_b32 s30, s32, 13
    s_add_u32 m0, s30, 129024
    s_cmp_lt_u32 s32, 2
    s_cselect_b32 s34, s16, s12
    s_cselect_b32 s35, s17, s13
    global_load_lds_dwordx4 v6, s[34:35]
    global_load_lds_dwordx4 v7, s[34:35] offset:1024
    global_load_lds_dwordx4 v8, s[34:35] offset:2048
    global_load_lds_dwordx4 v9, s[34:35] offset:3072
    s_add_u32 m0, m0, 4096
    s_add_u32 s34, s34, 8192
    s_addc_u32 s35, s35, 0
    global_load_lds_dwordx4 v6, s[34:35]
    global_load_lds_dwordx4 v7, s[34:35] offset:1024
    global_load_lds_dwordx4 v8, s[34:35] offset:2048
    global_load_lds_dwordx4 v9, s[34:35] offset:3072
    ds_read_b128 v[52:55], v12 offset:0
    ds_read_b128 v[56:59], v13 offset:0
    ds_read_b128 v[60:63], v14 offset:0
    ds_read_b128 v[64:67], v15 offset:0
    ds_read_b128 v[68:71], v12 offset:4096
    ds_read_b128 v[72:75], v13 offset:4096
    ds_read_b128 v[76:79], v14 offset:4096
    ds_read_b128 v[80:83], v15 offset:4096
    ds_read_b128 v[84:87], v12 offset:8192
    ds_read_b128 v[88:91], v13 offset:8192
    ds_read_b128 v[92:95], v14 offset:8192
    ds_read_b128 v[96:99], v15 offset:8192
    ds_read_b128 v[100:103], v12 offset:12288
    ds_read_b128 v[104:107], v13 offset:12288
    ds_read_b128 v[108:111], v14 offset:12288
    ds_read_b128 v[112:115], v15 offset:12288
    ds_read_b128 v[116:119], v12 offset:16384
    ds_read_b128 v[120:123], v13 offset:16384
    ds_read_b128 v[124:127], v14 offset:16384
    ds_read_b128 v[128:131], v15 offset:16384
    s_mov_b64 exec, 1
    ds_add_u32 v18, v19 offset:1540
    s_mov_b64 exec, -1
    s_mov_b64 exec, 1
    s_waitcnt vmcnt(0)
    ds_add_u32 v18, v19 offset:1540
    s_mov_b64 exec, -1
    s_sub_u32 s29, s3, 4
    v_and_b32 v3, 15, v1
    v_lshrrev_b32 v2, 4, v1
    v_lshl_add_u32 v159, v2, 3, v3
    s_lshl_b32 s30, s29, 5
    v_add_u32 v159, s30, v159
    s_lshl_b32 s30, s23, 3
    s_add_u32 s30, s30, 9437184
    v_lshl_add_u32 v160, v159, 10, s30
    v_cmp_gt_u32 s[66:67], 8, v3
    v_cmp_gt_u32 vcc, 250, v159
    v_mov_b32 v164, 0
    s_and_b64 s[66:67], s[66:67], vcc
    s_mov_b64 exec, s[66:67]
    global_load_dwordx2 v[164:165], v160, s[20:21] sc1
    s_mov_b64 exec, -1
    v_mul_u32_u24 v159, 3968, v159
    v_add_u32 v159, 1310720, v159
    v_mul_u32_u24 v157, 12, v3
    v_mul_u32_u24 v156, 3, v3
    v_not_b32 v156, v156
    v_subrev_u32 v158, 48, v156
    v_subrev_u32 v162, 1, v3
    v_ashrrev_i32 v162, 31, v162
    v_mov_b32 v161, 4
    v_mov_b32 v2, 0
    s_mov_b32 s31, 4000000
L_w_rd:
L_wf_rd:
    ds_read_b32 v3, v2 offset:1540
    s_sub_u32 s31, s31, 1
    s_cbranch_scc1 L_wd_rd
    s_waitcnt lgkmcnt(0)
    v_readfirstlane_b32 s30, v3
    s_and_b32 s30, s30, 255
    s_cmp_lg_u32 s30, 12
    s_cbranch_scc1 L_w_rd
L_wd_rd:
    ds_read_b64_tr_b16 v[20:21], v10 offset:0
    ds_read_b64_tr_b16 v[22:23], v10 offset:512
    ds_read_b64_tr_b16 v[36:37], v10 offset:16384
    ds_read_b64_tr_b16 v[38:39], v10 offset:16896
    ds_read_b64_tr_b16 v[24:25], v10 offset:4096
    ds_read_b64_tr_b16 v[26:27], v10 offset:4608
    ds_read_b64_tr_b16 v[40:41], v10 offset:20480
    ds_read_b64_tr_b16 v[42:43], v10 offset:20992
    ds_read_b64_tr_b16 v[28:29], v10 offset:8192
    ds_read_b64_tr_b16 v[30:31], v10 offset:8704
    ds_read_b64_tr_b16 v[44:45], v10 offset:24576
    ds_read_b64_tr_b16 v[46:47], v10 offset:25088
    ds_read_b64_tr_b16 v[32:33], v10 offset:12288
    ds_read_b64_tr_b16 v[34:35], v10 offset:12800
    ds_read_b64_tr_b16 v[48:49], v10 offset:28672
    ds_read_b64_tr_b16 v[50:51], v10 offset:29184
    s_waitcnt lgkmcnt(12)
    v_mfma_f32_16x16x32_bf16 v[132:135], v[20:23], v[52:55], 0
    v_mfma_f32_16x16x32_bf16 v[136:139], v[36:39], v[52:55], 0
    s_waitcnt lgkmcnt(8)
    v_mfma_f32_16x16x32_bf16 v[132:135], v[24:27], v[56:59], v[132:135]
    v_mfma_f32_16x16x32_bf16 v[136:139], v[40:43], v[56:59], v[136:139]
    s_waitcnt lgkmcnt(4)
    v_mfma_f32_16x16x32_bf16 v[132:135], v[28:31], v[60:63], v[132:135]
    v_mfma_f32_16x16x32_bf16 v[136:139], v[44:47], v[60:63], v[136:139]
    s_waitcnt lgkmcnt(0)
    v_mfma_f32_16x16x32_bf16 v[132:135], v[32:35], v[64:67], v[132:135]
    v_mfma_f32_16x16x32_bf16 v[136:139], v[48:51], v[64:67], v[136:139]
    v_mfma_f32_16x16x32_bf16 v[140:143], v[20:23], v[68:71], 0
    v_mfma_f32_16x16x32_bf16 v[144:147], v[36:39], v[68:71], 0
    v_mfma_f32_16x16x32_bf16 v[140:143], v[24:27], v[72:75], v[140:143]
    v_mfma_f32_16x16x32_bf16 v[144:147], v[40:43], v[72:75], v[144:147]
    v_mfma_f32_16x16x32_bf16 v[140:143], v[28:31], v[76:79], v[140:143]
    v_mfma_f32_16x16x32_bf16 v[144:147], v[44:47], v[76:79], v[144:147]
    v_mfma_f32_16x16x32_bf16 v[140:143], v[32:35], v[80:83], v[140:143]
    v_mfma_f32_16x16x32_bf16 v[144:147], v[48:51], v[80:83], v[144:147]
    v_mul_f32 v132, s40, v132
    v_mul_f32 v133, s40, v133
    v_mul_f32 v134, s40, v134
    v_mul_f32 v135, s40, v135
    v_mul_f32 v136, s42, v136
    v_mul_f32 v137, s42, v137
    v_mul_f32 v138, s42, v138
    v_mul_f32 v139, s42, v139
    v_cvt_pk_bf16_f32 v132, v132, v133
    v_cvt_pk_bf16_f32 v133, v134, v135
    v_cvt_f64_f32 v[2:3], v136
    v_cvt_f64_f32 v[4:5], v137
    v_cvt_f64_f32 v[6:7], v138
    v_cvt_f64_f32 v[8:9], v139
    ds_write_b64 v16, v[132:133] offset:512
    ds_write2_b64 v16, v[2:3], v[4:5] offset0:0 offset1:16
    ds_write2_b64 v16, v[6:7], v[8:9] offset0:32 offset1:48
    v_add_u32 v16, 10368, v16
    v_mfma_f32_16x16x32_bf16 v[148:151], v[20:23], v[84:87], 0
    v_mfma_f32_16x16x32_bf16 v[152:155], v[36:39], v[84:87], 0
    v_mfma_f32_16x16x32_bf16 v[148:151], v[24:27], v[88:91], v[148:151]
    v_mfma_f32_16x16x32_bf16 v[152:155], v[40:43], v[88:91], v[152:155]
    v_mfma_f32_16x16x32_bf16 v[148:151], v[28:31], v[92:95], v[148:151]
    v_mfma_f32_16x16x32_bf16 v[152:155], v[44:47], v[92:95], v[152:155]
    v_mfma_f32_16x16x32_bf16 v[148:151], v[32:35], v[96:99], v[148:151]
    v_mfma_f32_16x16x32_bf16 v[152:155], v[48:51], v[96:99], v[152:155]
    v_mul_f32 v140, s40, v140
    v_mul_f32 v141, s40, v141
    v_mul_f32 v142, s40, v142
    v_mul_f32 v143, s40, v143
    v_mul_f32 v144, s42, v144
    v_mul_f32 v145, s42, v145
    v_mul_f32 v146, s42, v146
    v_mul_f32 v147, s42, v147
    v_cvt_pk_bf16_f32 v140, v140, v141
    v_cvt_pk_bf16_f32 v141, v142, v143
    v_cvt_f64_f32 v[2:3], v144
    v_cvt_f64_f32 v[4:5], v145
    v_cvt_f64_f32 v[6:7], v146
    v_cvt_f64_f32 v[8:9], v147
    ds_write_b64 v16, v[140:141] offset:512
    ds_write2_b64 v16, v[2:3], v[4:5] offset0:0 offset1:16
    ds_write2_b64 v16, v[6:7], v[8:9] offset0:32 offset1:48
    v_add_u32 v16, 10368, v16
    v_mfma_f32_16x16x32_bf16 v[132:135], v[20:23], v[100:103], 0
    v_mfma_f32_16x16x32_bf16 v[136:139], v[36:39], v[100:103], 0
    v_mfma_f32_16x16x32_bf16 v[132:135], v[24:27], v[104:107], v[132:135]
    v_mfma_f32_16x16x32_bf16 v[136:139], v[40:43], v[104:107], v[136:139]
    v_mfma_f32_16x16x32_bf16 v[132:135], v[28:31], v[108:111], v[132:135]
    v_mfma_f32_16x16x32_bf16 v[136:139], v[44:47], v[108:111], v[136:139]
    v_mfma_f32_16x16x32_bf16 v[132:135], v[32:35], v[112:115], v[132:135]
    v_mfma_f32_16x16x32_bf16 v[136:139], v[48:51], v[112:115], v[136:139]
    v_mul_f32 v148, s40, v148
    v_mul_f32 v149, s40, v149
    v_mul_f32 v150, s40, v150
    v_mul_f32 v151, s40, v151
    v_mul_f32 v152, s42, v152
    v_mul_f32 v153, s42, v153
    v_mul_f32 v154, s42, v154
    v_mul_f32 v155, s42, v155
    v_cvt_pk_bf16_f32 v148, v148, v149
    v_cvt_pk_bf16_f32 v149, v150, v151
    v_cvt_f64_f32 v[2:3], v152
    v_cvt_f64_f32 v[4:5], v153
    v_cvt_f64_f32 v[6:7], v154
    v_cvt_f64_f32 v[8:9], v155
    ds_write_b64 v16, v[148:149] offset:512
    ds_write2_b64 v16, v[2:3], v[4:5] offset0:0 offset1:16
    ds_write2_b64 v16, v[6:7], v[8:9] offset0:32 offset1:48
    v_add_u32 v16, 10368, v16
    v_mfma_f32_16x16x32_bf16 v[140:143], v[20:23], v[116:119], 0
    v_mfma_f32_16x16x32_bf16 v[144:147], v[36:39], v[116:119], 0
    v_mfma_f32_16x16x32_bf16 v[140:143], v[24:27], v[120:123], v[140:143]
    v_mfma_f32_16x16x32_bf16 v[144:147], v[40:43], v[120:123], v[144:147]
    v_mfma_f32_16x16x32_bf16 v[140:143], v[28:31], v[124:127], v[140:143]
    v_mfma_f32_16x16x32_bf16 v[144:147], v[44:47], v[124:127], v[144:147]
    v_mfma_f32_16x16x32_bf16 v[140:143], v[32:35], v[128:131], v[140:143]
    v_mfma_f32_16x16x32_bf16 v[144:147], v[48:51], v[128:131], v[144:147]
    v_mul_f32 v132, s40, v132
    v_mul_f32 v133, s40, v133
    v_mul_f32 v134, s40, v134
    v_mul_f32 v135, s40, v135
    v_mul_f32 v136, s42, v136
    v_mul_f32 v137, s42, v137
    v_mul_f32 v138, s42, v138
    v_mul_f32 v139, s42, v139
    v_cvt_pk_bf16_f32 v132, v132, v133
    v_cvt_pk_bf16_f32 v133, v134, v135
    v_cvt_f64_f32 v[2:3], v136
    v_cvt_f64_f32 v[4:5], v137
    v_cvt_f64_f32 v[6:7], v138
    v_cvt_f64_f32 v[8:9], v139
    ds_write_b64 v16, v[132:133] offset:512
    ds_write2_b64 v16, v[2:3], v[4:5] offset0:0 offset1:16
    ds_write2_b64 v16, v[6:7], v[8:9] offset0:32 offset1:48
    v_add_u32 v16, 10368, v16
    v_mul_f32 v140, s40, v140
    v_mul_f32 v141, s40, v141
    v_mul_f32 v142, s40, v142
    v_mul_f32 v143, s40, v143
    v_mul_f32 v144, s42, v144
    v_mul_f32 v145, s42, v145
    v_mul_f32 v146, s42, v146
    v_mul_f32 v147, s42, v147
    v_cvt_pk_bf16_f32 v140, v140, v141
    v_cvt_pk_bf16_f32 v141, v142, v143
    v_cvt_f64_f32 v[2:3], v144
    v_cvt_f64_f32 v[4:5], v145
    v_cvt_f64_f32 v[6:7], v146
    v_cvt_f64_f32 v[8:9], v147
    ds_write_b64 v16, v[140:141] offset:512
    ds_write2_b64 v16, v[2:3], v[4:5] offset0:0 offset1:16
    ds_write2_b64 v16, v[6:7], v[8:9] offset0:32 offset1:48
    s_branch L_rec
L_sort:
    s_mov_b32 s40, 0xbfb8aa3b
    s_mov_b32 s46, 0x3f80
    s_cmp_lg_u32 s25, 0
    s_cbranch_scc1 L_sortskip
    v_mov_b32 v21, 1
    v_mov_b32 v20, 3
    s_mov_b32 s31, 52429
    s_movk_i32 s32, -20
    v_lshlrev_b32 v9, 3, v1
    v_lshlrev_b32 v33, 4, v0
    s_mul_i32 s30, s24, 15872
    s_add_u32 s30, s30, 5246976
    v_add_u32 v32, s30, v33
    v_add_u32 v34, 8192, v32
    s_lshl_b32 s30, s24, 10
    s_add_u32 s30, s30, 9437184
    v_lshl_add_u32 v42, v1, 4, s30
    s_mov_b32 s34, 4000000
    s_setprio 3
    v_mov_b32 v19, v3
    v_mov_b32 v2, 0
    s_mov_b32 s31, 4000000
L_w_ew:
L_wf_ew:
    ds_read_b32 v3, v2 offset:1536
    s_sub_u32 s31, s31, 1
    s_cbranch_scc1 L_wd_ew
    s_waitcnt lgkmcnt(0)
    v_readfirstlane_b32 s30, v3
    s_and_b32 s30, s30, 4278190080
    s_cmp_lg_u32 s30, 134217728
    s_cbranch_scc1 L_w_ew
L_wd_ew:
    v_mov_b32 v3, v19
    s_mov_b32 s31, 52429
    global_load_dwordx4 v[12:15], v3, s[8:9]
    global_load_dword v16, v18, s[8:9]
    global_load_dwordx4 v[52:55], v10, s[6:7]
    global_load_dwordx4 v[56:59], v10, s[6:7] offset:16
    global_load_dwordx2 v[60:61], v11, s[6:7]
    s_waitcnt vmcnt(5)
    v_mul_u32_u24 v22, s31, v4
    v_lshrrev_b32 v22, 22, v22
    v_lshlrev_b32 v22, 2, v22
    ds_add_rtn_u32 v27, v22, v20 offset:1024
    v_mul_u32_u24 v23, s31, v5
    v_lshrrev_b32 v23, 22, v23
    v_lshlrev_b32 v23, 2, v23
    ds_add_rtn_u32 v28, v23, v20 offset:1024
    v_mul_u32_u24 v24, s31, v6
    v_lshrrev_b32 v24, 22, v24
    v_lshlrev_b32 v24, 2, v24
    ds_add_rtn_u32 v29, v24, v20 offset:1024
    v_mul_u32_u24 v25, s31, v7
    v_lshrrev_b32 v25, 22, v25
    v_lshlrev_b32 v25, 2, v25
    ds_add_rtn_u32 v30, v25, v20 offset:1024
    v_mul_u32_u24 v26, s31, v8
    v_lshrrev_b32 v26, 22, v26
    v_lshlrev_b32 v26, 2, v26
    ds_add_rtn_u32 v31, v26, v20 offset:1024
    s_mov_b64 exec, 1
    s_cmp_lg_u32 s3, 0
    s_cbranch_scc1 L_notag
    s_waitcnt lgkmcnt(0)
    v_mov_b32 v43, s65
    ds_write_b32 v48, v43 offset:1524
L_notag:
    ds_add_u32 v48, v21 offset:1532
    s_mov_b64 exec, -1
L_s1:
    ds_read_b32 v38, v48 offset:1532
    ds_read_b64 v[36:37], v9 offset:1024
    s_sub_u32 s34, s34, 1
    s_cbranch_scc1 L_s1d
    s_waitcnt lgkmcnt(0)
    v_readfirstlane_b32 s30, v38
    s_cmp_lg_u32 s30, 4
    s_cbranch_scc1 L_s1
L_s1d:
    v_add3_u32 v39, v36, v37, 2
    v_add3_u32 v38, v36, v37, 2
    v_readlane_b32 s47, v37, 62
    v_add_u32_dpp v39, v39, v39 row_shr:1 row_mask:0xf bank_mask:0xf bound_ctrl:0
    v_mad_i32_i24 v4, v22, s32, v4
    v_lshlrev_b32 v4, 24, v4
    v_add_u32_dpp v39, v39, v39 row_shr:2 row_mask:0xf bank_mask:0xf bound_ctrl:0
    v_mad_i32_i24 v5, v23, s32, v5
    v_lshlrev_b32 v5, 24, v5
    v_add_u32_dpp v39, v39, v39 row_shr:4 row_mask:0xf bank_mask:0xf bound_ctrl:0
    v_mad_i32_i24 v6, v24, s32, v6
    v_lshlrev_b32 v6, 24, v6
    v_add_u32_dpp v39, v39, v39 row_shr:8 row_mask:0xf bank_mask:0xf bound_ctrl:0
    v_mad_i32_i24 v7, v25, s32, v7
    v_lshlrev_b32 v7, 24, v7
    v_add_u32_dpp v39, v39, v39 row_bcast:15 row_mask:0xa bank_mask:0xf
    v_mad_i32_i24 v8, v26, s32, v8
    v_lshlrev_b32 v8, 24, v8
    v_add_u32_dpp v39, v39, v39 row_bcast:31 row_mask:0xc bank_mask:0xf
    v_sub_u32 v40, v39, v38
    v_add3_u32 v41, v40, v36, 1
    s_mov_b32 s30, 32032
    v_lshl_add_u32 v38, v40, 2, s30
    v_lshl_add_u32 v39, v41, 2, s30
    ds_write_b64 v9, v[38:39] offset:512
    ds_read_b32 v22, v22 offset:512
    ds_read_b32 v23, v23 offset:512
    ds_read_b32 v24, v24 offset:512
    ds_read_b32 v25, v25 offset:512
    ds_read_b32 v26, v26 offset:512
    s_mul_i32 s27, s47, 0x85ebca6b
    s_mul_i32 s26, s47, 0x9e3779b1
    s_add_u32 s27, s27, 0x5bd1e995
    s_add_u32 s26, s26, 0x7f4a7c15
    s_cmp_lg_u32 s3, 0
    s_cbranch_scc1 L_nopub
    s_and_b32 s35, s27, 0xff000000
    v_mov_b32 v45, s26
    v_mov_b32 v47, s26
    v_lshl_or_b32 v44, v36, 12, v40
    v_lshl_or_b32 v46, v37, 12, v41
    v_or_b32 v44, s35, v44
    v_or_b32 v46, s35, v46
    global_store_dwordx4 v42, v[44:47], s[20:21] sc1
    s_waitcnt vmcnt(1)
    s_branch L_pub
L_nopub:
    s_cmp_lg_u32 s3, 1
    s_cbranch_scc1 L_nochk
    v_mov_b32 v44, s27
    s_mov_b32 exec_hi, 0x7fffffff
    ds_add_u32 v38, v44
    ds_add_u32 v39, v44
    s_mov_b32 exec_hi, -1
L_nochk:
    s_waitcnt vmcnt(0)
L_pub:
    v_lshl_or_b32 v4, v12, 8, v4
    v_lshl_or_b32 v5, v13, 8, v5
    v_lshl_or_b32 v6, v14, 8, v6
    v_lshl_or_b32 v7, v15, 8, v7
    v_lshl_or_b32 v8, v16, 8, v8
    s_waitcnt lgkmcnt(0)
    v_lshl_add_u32 v27, v27, 2, v22
    v_add3_u32 v12, v52, v53, v4
    ds_write2_b32 v27, v52, v53 offset0:2 offset1:3
    ds_write_b32 v27, v4 offset:4
    ds_sub_u32 v22, v12
    v_lshl_add_u32 v28, v28, 2, v23
    v_add3_u32 v13, v54, v55, v5
    ds_write2_b32 v28, v54, v55 offset0:2 offset1:3
    ds_write_b32 v28, v5 offset:4
    ds_sub_u32 v23, v13
    v_lshl_add_u32 v29, v29, 2, v24
    v_add3_u32 v14, v56, v57, v6
    ds_write2_b32 v29, v56, v57 offset0:2 offset1:3
    ds_write_b32 v29, v6 offset:4
    ds_sub_u32 v24, v14
    v_lshl_add_u32 v30, v30, 2, v25
    v_add3_u32 v15, v58, v59, v7
    ds_write2_b32 v30, v58, v59 offset0:2 offset1:3
    ds_write_b32 v30, v7 offset:4
    ds_sub_u32 v25, v15
    v_lshl_add_u32 v31, v31, 2, v26
    v_add3_u32 v16, v60, v61, v8
    ds_write2_b32 v31, v60, v61 offset0:2 offset1:3
    ds_write_b32 v31, v8 offset:4
    ds_sub_u32 v26, v16
    s_mov_b64 exec, 1
    ds_add_u32 v48, v21 offset:1528
    s_mov_b64 exec, -1
    s_mov_b32 s34, 4000000
L_s2:
    ds_read_b32 v38, v48 offset:1528
    ds_read_b128 v[72:75], v33 offset:32032
    s_sub_u32 s34, s34, 1
    s_cbranch_scc1 L_s2d
    s_waitcnt lgkmcnt(1)
    v_readfirstlane_b32 s30, v38
    s_cmp_lg_u32 s30, 4
    s_cbranch_scc1 L_s2
L_s2d:
    ds_read_b128 v[76:79], v33 offset:36128
    ds_read_b128 v[80:83], v33 offset:40224
    ds_read_b128 v[84:87], v33 offset:44320
    s_waitcnt lgkmcnt(3)
    global_store_dwordx4 v32, v[72:75], s[20:21] offset:-4096 sc1
    s_waitcnt lgkmcnt(2)
    global_store_dwordx4 v32, v[76:79], s[20:21] sc1
    s_waitcnt lgkmcnt(1)
    global_store_dwordx4 v34, v[80:83], s[20:21] offset:-4096 sc1
    s_cmp_eq_u32 s3, 3
    s_cselect_b32 exec_hi, 0, -1
    s_waitcnt lgkmcnt(0)
    global_store_dwordx4 v34, v[84:87], s[20:21] sc1
    s_mov_b32 exec_hi, -1
    ds_write_b128 v33, v[48:51] offset:32032
    ds_write_b128 v33, v[48:51] offset:36128
    ds_write_b128 v33, v[48:51] offset:40224
    ds_write_b128 v33, v[48:51] offset:44320
    s_branch L_sortdone
L_sortskip:
    s_waitcnt vmcnt(0)
L_sortdone:
    s_mov_b32 s29, s3
    v_and_b32 v3, 15, v1
    v_lshrrev_b32 v2, 4, v1
    v_lshl_add_u32 v159, v2, 3, v3
    s_lshl_b32 s30, s29, 5
    v_add_u32 v159, s30, v159
    s_lshl_b32 s30, s23, 3
    s_add_u32 s30, s30, 9437184
    v_lshl_add_u32 v160, v159, 10, s30
    v_cmp_gt_u32 s[66:67], 8, v3
    v_cmp_gt_u32 vcc, 250, v159
    v_mov_b32 v164, 0
    s_and_b64 s[66:67], s[66:67], vcc
    s_mov_b64 exec, s[66:67]
    global_load_dwordx2 v[164:165], v160, s[20:21] sc1
    s_mov_b64 exec, -1
    v_mul_u32_u24 v159, 3968, v159
    v_add_u32 v159, 1310720, v159
    v_mul_u32_u24 v157, 12, v3
    v_mul_u32_u24 v156, 3, v3
    v_not_b32 v156, v156
    v_subrev_u32 v158, 48, v156
    v_subrev_u32 v162, 1, v3
    v_ashrrev_i32 v162, 31, v162
    v_mov_b32 v161, 4
L_rec:
    s_cmp_ge_u32 s3, 8
    s_cbranch_scc1 L_nomc
    v_mov_b32 v2, 0
    s_mov_b32 s31, 4000000
L_w_r0:
L_wf_r0:
    ds_read_b32 v3, v2 offset:1536
    s_sub_u32 s31, s31, 1
    s_cbranch_scc1 L_wd_r0
    s_waitcnt lgkmcnt(0)
    v_readfirstlane_b32 s30, v3
    s_and_b32 s30, s30, 255
    s_cmp_lg_u32 s30, 8
    s_cbranch_scc1 L_w_r0
L_wd_r0:
L_nomc:
    s_cmp_ge_u32 s3, 4
    s_cbranch_scc1 L_nod2
    v_mov_b32 v2, 0
    v_mov_b32 v3, 0x100
    s_mov_b64 exec, 1
    s_waitcnt vmcnt(0)
    ds_add_u32 v2, v3 offset:1536
    s_mov_b64 exec, -1
L_nod2:
    s_cmp_lg_u32 s25, 0
    s_cbranch_scc1 L_recskip
    s_lshr_b32 s35, s27, 24
    s_mov_b64 exec, s[66:67]
    s_mov_b32 s34, 200000
    s_branch L_p1c
L_p1:
    global_load_dwordx2 v[164:165], v160, s[20:21] sc1
L_p1c:
    s_sub_u32 s34, s34, 1
    s_cbranch_scc1 L_toobig
    s_waitcnt vmcnt(0)
    v_cmp_ne_u32 vcc, s26, v165
    v_cmp_ne_u32_sdwa s[48:49], v164, s35 src0_sel:BYTE_3 src1_sel:DWORD
    s_or_b64 exec, vcc, s[48:49]
    s_cbranch_scc1 L_p1
    s_mov_b64 exec, -1
    v_and_b32 v166, 0xfff, v164
    v_bfe_u32 v164, v164, 12, 12
    v_add_lshl_u32 v166, v166, v159, 2
    v_cmp_ne_u32 vcc, 0, v164
    s_sub_u32 s30, 0, s27
    v_mov_b32 v2, s30
    v_cndmask_b32 v165, 0, v2, vcc
    v_cmp_lt_u32 vcc, 96, v164
    v_cmp_lt_u32 s[68:69], 48, v164
    s_cbranch_vccnz L_toobig
    v_add_co_u32_dpp v2, vcc, v164, v156 row_newbcast:0 row_mask:0xf bank_mask:0xf
    v_add_u32_dpp v136, v166, v157 row_newbcast:0 row_mask:0xf bank_mask:0xf
    s_mov_b64 s[48:49], vcc
    v_add_co_u32_dpp v2, vcc, v164, v156 row_newbcast:1 row_mask:0xf bank_mask:0xf
    v_add_u32_dpp v137, v166, v157 row_newbcast:1 row_mask:0xf bank_mask:0xf
    s_mov_b64 s[50:51], vcc
    v_add_co_u32_dpp v2, vcc, v164, v156 row_newbcast:2 row_mask:0xf bank_mask:0xf
    v_add_u32_dpp v138, v166, v157 row_newbcast:2 row_mask:0xf bank_mask:0xf
    s_mov_b64 s[52:53], vcc
    v_add_co_u32_dpp v2, vcc, v164, v156 row_newbcast:3 row_mask:0xf bank_mask:0xf
    v_add_u32_dpp v139, v166, v157 row_newbcast:3 row_mask:0xf bank_mask:0xf
    s_mov_b64 s[54:55], vcc
    v_add_co_u32_dpp v2, vcc, v164, v156 row_newbcast:4 row_mask:0xf bank_mask:0xf
    v_add_u32_dpp v140, v166, v157 row_newbcast:4 row_mask:0xf bank_mask:0xf
    s_mov_b64 s[56:57], vcc
    v_add_co_u32_dpp v2, vcc, v164, v156 row_newbcast:5 row_mask:0xf bank_mask:0xf
    v_add_u32_dpp v141, v166, v157 row_newbcast:5 row_mask:0xf bank_mask:0xf
    s_mov_b64 s[58:59], vcc
    v_add_co_u32_dpp v2, vcc, v164, v156 row_newbcast:6 row_mask:0xf bank_mask:0xf
    v_add_u32_dpp v142, v166, v157 row_newbcast:6 row_mask:0xf bank_mask:0xf
    s_mov_b64 s[60:61], vcc
    v_add_co_u32_dpp v2, vcc, v164, v156 row_newbcast:7 row_mask:0xf bank_mask:0xf
    v_add_u32_dpp v143, v166, v157 row_newbcast:7 row_mask:0xf bank_mask:0xf
    s_mov_b64 s[62:63], vcc
    v_mov_b32 v2, 0
    s_mov_b32 s31, 4000000
L_w_r1:
L_wf_r1:
    ds_read_b32 v3, v2 offset:1536
    s_sub_u32 s31, s31, 1
    s_cbranch_scc1 L_wd_r1
    s_waitcnt lgkmcnt(0)
    v_readfirstlane_b32 s30, v3
    s_and_b32 s30, s30, 65280
    s_cmp_lg_u32 s30, 1024
    s_cbranch_scc1 L_w_r1
L_wd_r1:
    s_or_b32 s68, s68, s69
    s_lshr_b32 s69, s68, 16
    s_or_b32 s68, s68, s69
    s_and_b32 s30, s68, 7
    s_cbranch_scc0 L_nxm
    s_bitcmp1_b32 s68, 0
    s_cbranch_scc0 L_nxm0
    v_add_co_u32_dpp v2, vcc, v164, v158 row_newbcast:0 row_mask:0xf bank_mask:0xf
    s_mov_b64 exec, vcc
    global_load_dwordx4 v[104:107], v136, s[20:21] offset:192 sc1
    s_mov_b64 exec, -1
L_nxm0:
    s_bitcmp1_b32 s68, 1
    s_cbranch_scc0 L_nxm1
    v_add_co_u32_dpp v2, vcc, v164, v158 row_newbcast:1 row_mask:0xf bank_mask:0xf
    s_mov_b64 exec, vcc
    global_load_dwordx4 v[108:111], v137, s[20:21] offset:192 sc1
    s_mov_b64 exec, -1
L_nxm1:
    s_bitcmp1_b32 s68, 2
    s_cbranch_scc0 L_nxm2
    v_add_co_u32_dpp v2, vcc, v164, v158 row_newbcast:2 row_mask:0xf bank_mask:0xf
    s_mov_b64 exec, vcc
    global_load_dwordx4 v[112:115], v138, s[20:21] offset:192 sc1
    s_mov_b64 exec, -1
L_nxm2:
L_nxm:
    s_mov_b64 exec, s[48:49]
    global_load_dwordx4 v[72:75], v136, s[20:21] sc1
    s_mov_b64 exec, s[50:51]
    global_load_dwordx4 v[76:79], v137, s[20:21] sc1
    s_mov_b64 exec, s[52:53]
    global_load_dwordx4 v[80:83], v138, s[20:21] sc1
    s_mov_b64 exec, -1
    v_mov_b32 v2, 0
    ds_read_b32 v3, v2 offset:1544
    s_waitcnt lgkmcnt(0)
    v_readfirstlane_b32 s73, v3
    s_cmp_lg_u32 s73, 5
    s_cbranch_scc1 L_neag
    s_and_b32 s30, s68, 248
    s_cbranch_scc0 L_nxe
    s_bitcmp1_b32 s68, 3
    s_cbranch_scc0 L_nxe3
    v_add_co_u32_dpp v2, vcc, v164, v158 row_newbcast:3 row_mask:0xf bank_mask:0xf
    s_mov_b64 exec, vcc
    global_load_dwordx4 v[116:119], v139, s[20:21] offset:192 sc1
    s_mov_b64 exec, -1
L_nxe3:
    s_bitcmp1_b32 s68, 4
    s_cbranch_scc0 L_nxe4
    v_add_co_u32_dpp v2, vcc, v164, v158 row_newbcast:4 row_mask:0xf bank_mask:0xf
    s_mov_b64 exec, vcc
    global_load_dwordx4 v[120:123], v140, s[20:21] offset:192 sc1
    s_mov_b64 exec, -1
L_nxe4:
    s_bitcmp1_b32 s68, 5
    s_cbranch_scc0 L_nxe5
    v_add_co_u32_dpp v2, vcc, v164, v158 row_newbcast:5 row_mask:0xf bank_mask:0xf
    s_mov_b64 exec, vcc
    global_load_dwordx4 v[124:127], v141, s[20:21] offset:192 sc1
    s_mov_b64 exec, -1
L_nxe5:
    s_bitcmp1_b32 s68, 6
    s_cbranch_scc0 L_nxe6
    v_add_co_u32_dpp v2, vcc, v164, v158 row_newbcast:6 row_mask:0xf bank_mask:0xf
    s_mov_b64 exec, vcc
    global_load_dwordx4 v[128:131], v142, s[20:21] offset:192 sc1
    s_mov_b64 exec, -1
L_nxe6:
    s_bitcmp1_b32 s68, 7
    s_cbranch_scc0 L_nxe7
    v_add_co_u32_dpp v2, vcc, v164, v158 row_newbcast:7 row_mask:0xf bank_mask:0xf
    s_mov_b64 exec, vcc
    global_load_dwordx4 v[132:135], v143, s[20:21] offset:192 sc1
    s_mov_b64 exec, -1
L_nxe7:
L_nxe:
    s_mov_b64 exec, s[54:55]
    global_load_dwordx4 v[84:87], v139, s[20:21] sc1
    s_mov_b64 exec, s[56:57]
    global_load_dwordx4 v[88:91], v140, s[20:21] sc1
    s_mov_b64 exec, s[58:59]
    global_load_dwordx4 v[92:95], v141, s[20:21] sc1
    s_mov_b64 exec, s[60:61]
    global_load_dwordx4 v[96:99], v142, s[20:21] sc1
    s_mov_b64 exec, s[62:63]
    global_load_dwordx4 v[100:103], v143, s[20:21] sc1
    s_mov_b64 exec, -1
L_neag:
    v_and_b32 v2, 15, v1
    v_lshrrev_b32 v3, 4, v1
    v_lshl_add_u32 v3, v2, 2, v3
    v_lshlrev_b32 v3, 1, v3
    v_add_u32 v3, 161792, v3
    ds_read_u16 v64, v3
    ds_read_u16 v65, v3 offset:128
    ds_read_u16 v66, v3 offset:256
    ds_read_u16 v67, v3 offset:384
    v_and_b32 v63, 3, v1
    v_lshlrev_b32 v20, 3, v2
    v_lshlrev_b32 v21, 3, v2
    v_lshlrev_b32 v14, 4, v2
    v_lshlrev_b32 v15, 4, v2
    v_mov_b32 v12, 0x8888
    v_bfe_u32 v60, v1, 3, 2
    v_bfe_u32 v61, v1, 2, 1
    v_lshrrev_b32 v62, 5, v1
    v_and_b32 v2, 1, v60
    v_lshlrev_b32 v2, 4, v2
    v_lshlrev_b32 v2, v2, s46
    v_lshrrev_b32 v60, 1, v60
    v_lshl_add_u32 v3, v61, 1, v60
    v_sub_u32 v63, v63, v62
    v_lshl_add_u32 v3, v63, 1, v3
    v_and_b32 v63, 1, v63
    v_lshl_or_b32 v3, v63, 4, v3
    v_xor_b32 v61, v61, v62
    v_lshl_or_b32 v60, v61, 4, v60
    v_cmp_eq_u32 s[28:29], 0, v3
    v_cmp_eq_u32 s[30:31], 1, v3
    v_cmp_eq_u32 s[32:33], 2, v3
    v_cmp_eq_u32 vcc, 3, v3
    v_cndmask_b32 v4, 0, v2, s[28:29]
    v_cndmask_b32 v5, 0, v2, s[30:31]
    v_cndmask_b32 v6, 0, v2, s[32:33]
    v_cndmask_b32 v7, 0, v2, vcc
    v_cmp_eq_u32 s[28:29], 4, v3
    v_cmp_eq_u32 s[30:31], 5, v3
    v_cmp_eq_u32 s[32:33], 6, v3
    v_cmp_eq_u32 vcc, 7, v3
    v_cndmask_b32 v8, 0, v2, s[28:29]
    v_cndmask_b32 v9, 0, v2, s[30:31]
    v_cndmask_b32 v10, 0, v2, s[32:33]
    v_cndmask_b32 v11, 0, v2, vcc
    v_cmp_eq_u32 s[28:29], 0, v60
    v_cmp_eq_u32 s[30:31], 1, v60
    v_and_b32 v63, 3, v1
    v_lshlrev_b32 v61, 3, v63
    v_cndmask_b32 v16, 0, v2, s[28:29]
    v_cndmask_b32 v17, 0, v2, s[30:31]
    v_add_u32 v13, 11552, v61
    s_lshl_b32 s30, s3, 9
    s_sub_u32 s31, s30, 4096
    s_max_i32 s31, s31, 0
    s_add_u32 s30, s30, s31
    s_add_u32 s30, s30, 2048
    v_lshrrev_b32 v2, 4, v1
    v_lshl_add_u32 v22, v2, 4, s30
    v_bfe_u32 v3, v1, 2, 2
    v_lshl_add_u32 v23, v3, 4, s30
    v_lshl_add_u32 v23, v2, 2, v23
    s_lshl_b32 s30, s3, 2
    s_add_u32 s30, s30, 32
    v_add_u32 v2, s30, v2
    v_mul_u32_u24 v68, 648, v2
    v_add_u32 v68, v68, v20
    v_add_u32 v68, 55040, v68
    s_mul_i32 s30, s23, 20480
    s_lshl_b32 s31, s22, 7
    s_add_u32 s30, s30, s31
    v_lshl_add_u32 v69, v2, 8, v20
    v_add_u32 v69, s30, v69
    s_waitcnt lgkmcnt(0)
    v_lshlrev_b32 v60, 16, v64
    v_lshlrev_b32 v61, 16, v65
    v_lshlrev_b32 v62, 16, v66
    v_lshlrev_b32 v63, 16, v67
    v_mul_f32 v60, s40, v60
    v_mul_f32 v61, s40, v61
    v_mul_f32 v62, s40, v62
    v_mul_f32 v63, s40, v63
    v_cvt_pk_bf16_f32 v18, v60, v61
    v_cvt_pk_bf16_f32 v19, v62, v63
L_nomc2:
L_ck0:
    s_mov_b32 vcc_lo, 458759
    s_mov_b32 vcc_hi, 458759
    v_cndmask_b32 v163, 0, v165, vcc
    s_and_b32 s30, s68, 7
    s_cbranch_scc1 L_xa0
L_xb0:
    s_waitcnt vmcnt(2)
    s_mov_b64 exec, s[48:49]
    v_and_b32 v72, v72, v162
    v_add3_u32 v163, v163, v74, v75
    v_add3_u32 v163, v163, v72, v73
    s_waitcnt vmcnt(1)
    s_mov_b64 exec, s[50:51]
    v_and_b32 v76, v76, v162
    v_add3_u32 v163, v163, v78, v79
    v_add3_u32 v163, v163, v76, v77
    s_waitcnt vmcnt(0)
    s_mov_b64 exec, s[52:53]
    v_and_b32 v80, v80, v162
    v_add3_u32 v163, v163, v82, v83
    v_add3_u32 v163, v163, v80, v81
    s_mov_b64 exec, -1
    s_nop 0
    v_add_u32_dpp v163, v163, v163 row_ror:1 row_mask:0xf bank_mask:0xf
    s_nop 1
    v_add_u32_dpp v163, v163, v163 row_ror:2 row_mask:0xf bank_mask:0xf
    s_nop 1
    v_add_u32_dpp v163, v163, v163 row_ror:4 row_mask:0xf bank_mask:0xf
    s_nop 1
    v_add_u32_dpp v163, v163, v163 row_ror:8 row_mask:0xf bank_mask:0xf
    v_cmp_ne_u32 vcc, 0, v163
    s_cbranch_vccnz L_rt0
    s_mov_b64 exec, s[48:49]
    v_mul_u32_u24_sdwa v72, v161, v73 dst_sel:DWORD dst_unused:UNUSED_PAD src0_sel:DWORD src1_sel:BYTE_3
    v_and_b32 v73, 4194048, v73
    ds_add_rtn_u32 v72, v72, v161 offset:0
    s_mov_b64 exec, s[50:51]
    v_mul_u32_u24_sdwa v76, v161, v77 dst_sel:DWORD dst_unused:UNUSED_PAD src0_sel:DWORD src1_sel:BYTE_3
    v_and_b32 v77, 4194048, v77
    ds_add_rtn_u32 v76, v76, v161 offset:0
    s_mov_b64 exec, s[52:53]
    v_mul_u32_u24_sdwa v80, v161, v81 dst_sel:DWORD dst_unused:UNUSED_PAD src0_sel:DWORD src1_sel:BYTE_3
    v_and_b32 v81, 4194048, v81
    ds_add_rtn_u32 v80, v80, v161 offset:0
    s_and_b32 s30, s68, 7
    s_cbranch_scc1 L_ya0
L_yb0:
    s_waitcnt lgkmcnt(2)
    s_mov_b64 exec, s[48:49]
    v_lshlrev_b32 v2, 1, v72
    ds_write_b32 v72, v73
    ds_write_b64 v2, v[74:75] offset:11552
    s_waitcnt lgkmcnt(3)
    s_mov_b64 exec, s[50:51]
    v_lshlrev_b32 v2, 1, v76
    ds_write_b32 v76, v77
    ds_write_b64 v2, v[78:79] offset:11552
    s_waitcnt lgkmcnt(4)
    s_mov_b64 exec, s[52:53]
    v_lshlrev_b32 v2, 1, v80
    ds_write_b32 v80, v81
    ds_write_b64 v2, v[82:83] offset:11552
    s_mov_b64 exec, -1
    s_cmp_eq_u32 s73, 5
    s_cbranch_scc1 L_eagd
    v_mov_b32 v2, 0
    s_mov_b32 s31, 4000000
L_w_g2:
L_wf_g2:
    ds_read_b32 v3, v2 offset:1544
    s_sub_u32 s31, s31, 1
    s_cbranch_scc1 L_wd_g2
    s_waitcnt lgkmcnt(0)
    v_readfirstlane_b32 s30, v3
    s_and_b32 s30, s30, 255
    s_cmp_lg_u32 s30, 5
    s_cbranch_scc1 L_w_g2
L_wd_g2:
    s_and_b32 s30, s68, 248
    s_cbranch_scc0 L_nxn
    s_bitcmp1_b32 s68, 3
    s_cbranch_scc0 L_nxn3
    v_add_co_u32_dpp v2, vcc, v164, v158 row_newbcast:3 row_mask:0xf bank_mask:0xf
    s_mov_b64 exec, vcc
    global_load_dwordx4 v[116:119], v139, s[20:21] offset:192 sc1
    s_mov_b64 exec, -1
L_nxn3:
    s_bitcmp1_b32 s68, 4
    s_cbranch_scc0 L_nxn4
    v_add_co_u32_dpp v2, vcc, v164, v158 row_newbcast:4 row_mask:0xf bank_mask:0xf
    s_mov_b64 exec, vcc
    global_load_dwordx4 v[120:123], v140, s[20:21] offset:192 sc1
    s_mov_b64 exec, -1
L_nxn4:
    s_bitcmp1_b32 s68, 5
    s_cbranch_scc0 L_nxn5
    v_add_co_u32_dpp v2, vcc, v164, v158 row_newbcast:5 row_mask:0xf bank_mask:0xf
    s_mov_b64 exec, vcc
    global_load_dwordx4 v[124:127], v141, s[20:21] offset:192 sc1
    s_mov_b64 exec, -1
L_nxn5:
    s_bitcmp1_b32 s68, 6
    s_cbranch_scc0 L_nxn6
    v_add_co_u32_dpp v2, vcc, v164, v158 row_newbcast:6 row_mask:0xf bank_mask:0xf
    s_mov_b64 exec, vcc
    global_load_dwordx4 v[128:131], v142, s[20:21] offset:192 sc1
    s_mov_b64 exec, -1
L_nxn6:
    s_bitcmp1_b32 s68, 7
    s_cbranch_scc0 L_nxn7
    v_add_co_u32_dpp v2, vcc, v164, v158 row_newbcast:7 row_mask:0xf bank_mask:0xf
    s_mov_b64 exec, vcc
    global_load_dwordx4 v[132:135], v143, s[20:21] offset:192 sc1
    s_mov_b64 exec, -1
L_nxn7:
L_nxn:
    s_mov_b64 exec, s[54:55]
    global_load_dwordx4 v[84:87], v139, s[20:21] sc1
    s_mov_b64 exec, s[56:57]
    global_load_dwordx4 v[88:91], v140, s[20:21] sc1
    s_mov_b64 exec, s[58:59]
    global_load_dwordx4 v[92:95], v141, s[20:21] sc1
    s_mov_b64 exec, s[60:61]
    global_load_dwordx4 v[96:99], v142, s[20:21] sc1
    s_mov_b64 exec, s[62:63]
    global_load_dwordx4 v[100:103], v143, s[20:21] sc1
    s_mov_b64 exec, -1
L_eagd:
L_ck1:
    s_mov_b32 vcc_lo, 3670072
    s_mov_b32 vcc_hi, 3670072
    v_cndmask_b32 v163, 0, v165, vcc
    s_and_b32 s30, s68, 56
    s_cbranch_scc1 L_xa1
L_xb1:
    s_waitcnt vmcnt(4)
    s_mov_b64 exec, s[54:55]
    v_and_b32 v84, v84, v162
    v_add3_u32 v163, v163, v86, v87
    v_add3_u32 v163, v163, v84, v85
    s_waitcnt vmcnt(3)
    s_mov_b64 exec, s[56:57]
    v_and_b32 v88, v88, v162
    v_add3_u32 v163, v163, v90, v91
    v_add3_u32 v163, v163, v88, v89
    s_waitcnt vmcnt(2)
    s_mov_b64 exec, s[58:59]
    v_and_b32 v92, v92, v162
    v_add3_u32 v163, v163, v94, v95
    v_add3_u32 v163, v163, v92, v93
    s_mov_b64 exec, -1
    s_nop 0
    v_add_u32_dpp v163, v163, v163 row_ror:1 row_mask:0xf bank_mask:0xf
    s_nop 1
    v_add_u32_dpp v163, v163, v163 row_ror:2 row_mask:0xf bank_mask:0xf
    s_nop 1
    v_add_u32_dpp v163, v163, v163 row_ror:4 row_mask:0xf bank_mask:0xf
    s_nop 1
    v_add_u32_dpp v163, v163, v163 row_ror:8 row_mask:0xf bank_mask:0xf
    v_cmp_ne_u32 vcc, 0, v163
    s_cbranch_vccnz L_rt1
    v_mov_b32 v2, 0
    v_mov_b32 v3, 0x10000
    s_mov_b64 exec, 1
    ds_add_u32 v2, v3 offset:1536
    s_mov_b64 exec, -1
    s_mov_b64 exec, s[54:55]
    v_mul_u32_u24_sdwa v84, v161, v85 dst_sel:DWORD dst_unused:UNUSED_PAD src0_sel:DWORD src1_sel:BYTE_3
    v_and_b32 v85, 4194048, v85
    ds_add_rtn_u32 v84, v84, v161 offset:0
    s_mov_b64 exec, s[56:57]
    v_mul_u32_u24_sdwa v88, v161, v89 dst_sel:DWORD dst_unused:UNUSED_PAD src0_sel:DWORD src1_sel:BYTE_3
    v_and_b32 v89, 4194048, v89
    ds_add_rtn_u32 v88, v88, v161 offset:0
    s_mov_b64 exec, s[58:59]
    v_mul_u32_u24_sdwa v92, v161, v93 dst_sel:DWORD dst_unused:UNUSED_PAD src0_sel:DWORD src1_sel:BYTE_3
    v_and_b32 v93, 4194048, v93
    ds_add_rtn_u32 v92, v92, v161 offset:0
    s_and_b32 s30, s68, 56
    s_cbranch_scc1 L_ya1
L_yb1:
    s_waitcnt lgkmcnt(2)
    s_mov_b64 exec, s[54:55]
    v_lshlrev_b32 v2, 1, v84
    ds_write_b32 v84, v85
    ds_write_b64 v2, v[86:87] offset:11552
    s_waitcnt lgkmcnt(3)
    s_mov_b64 exec, s[56:57]
    v_lshlrev_b32 v2, 1, v88
    ds_write_b32 v88, v89
    ds_write_b64 v2, v[90:91] offset:11552
    s_waitcnt lgkmcnt(4)
    s_mov_b64 exec, s[58:59]
    v_lshlrev_b32 v2, 1, v92
    ds_write_b32 v92, v93
    ds_write_b64 v2, v[94:95] offset:11552
    s_mov_b64 exec, -1
L_ck2:
    s_mov_b32 vcc_lo, 12583104
    s_mov_b32 vcc_hi, 12583104
    v_cndmask_b32 v163, 0, v165, vcc
    s_and_b32 s30, s68, 192
    s_cbranch_scc1 L_xa2
L_xb2:
    s_waitcnt vmcnt(1)
    s_mov_b64 exec, s[60:61]
    v_and_b32 v96, v96, v162
    v_add3_u32 v163, v163, v98, v99
    v_add3_u32 v163, v163, v96, v97
    s_waitcnt vmcnt(0)
    s_mov_b64 exec, s[62:63]
    v_and_b32 v100, v100, v162
    v_add3_u32 v163, v163, v102, v103
    v_add3_u32 v163, v163, v100, v101
    s_mov_b64 exec, -1
    s_nop 0
    v_add_u32_dpp v163, v163, v163 row_ror:1 row_mask:0xf bank_mask:0xf
    s_nop 1
    v_add_u32_dpp v163, v163, v163 row_ror:2 row_mask:0xf bank_mask:0xf
    s_nop 1
    v_add_u32_dpp v163, v163, v163 row_ror:4 row_mask:0xf bank_mask:0xf
    s_nop 1
    v_add_u32_dpp v163, v163, v163 row_ror:8 row_mask:0xf bank_mask:0xf
    v_cmp_ne_u32 vcc, 0, v163
    s_cbranch_vccnz L_rt2
    s_mov_b64 exec, s[60:61]
    v_mul_u32_u24_sdwa v96, v161, v97 dst_sel:DWORD dst_unused:UNUSED_PAD src0_sel:DWORD src1_sel:BYTE_3
    v_and_b32 v97, 4194048, v97
    ds_add_rtn_u32 v96, v96, v161 offset:0
    s_mov_b64 exec, s[62:63]
    v_mul_u32_u24_sdwa v100, v161, v101 dst_sel:DWORD dst_unused:UNUSED_PAD src0_sel:DWORD src1_sel:BYTE_3
    v_and_b32 v101, 4194048, v101
    ds_add_rtn_u32 v100, v100, v161 offset:0
    s_and_b32 s30, s68, 192
    s_cbranch_scc1 L_ya2
L_yb2:
    s_waitcnt lgkmcnt(1)
    s_mov_b64 exec, s[60:61]
    v_lshlrev_b32 v2, 1, v96
    ds_write_b32 v96, v97
    ds_write_b64 v2, v[98:99] offset:11552
    s_waitcnt lgkmcnt(2)
    s_mov_b64 exec, s[62:63]
    v_lshlrev_b32 v2, 1, v100
    ds_write_b32 v100, v101
    ds_write_b64 v2, v[102:103] offset:11552
    s_mov_b64 exec, -1
    s_branch L_b4
L_toobig:
    s_mov_b64 exec, -1
    v_mov_b32 v2, 0
    v_mov_b32 v3, 0x10000
    s_mov_b64 exec, 1
    ds_add_u32 v2, v3 offset:1536
    s_mov_b64 exec, -1
L_giveup:
    v_mov_b32 v2, 0
    ds_write_b32 v2, v161 offset:1548
L_recskip:
    s_waitcnt vmcnt(0)
    v_and_b32 v2, 15, v1
    v_lshrrev_b32 v3, 4, v1
    v_lshl_add_u32 v3, v2, 2, v3
    v_lshlrev_b32 v3, 1, v3
    v_add_u32 v3, 161792, v3
    ds_read_u16 v64, v3
    ds_read_u16 v65, v3 offset:128
    ds_read_u16 v66, v3 offset:256
    ds_read_u16 v67, v3 offset:384
    v_and_b32 v63, 3, v1
    v_lshlrev_b32 v20, 3, v2
    v_lshlrev_b32 v21, 3, v2
    v_lshlrev_b32 v14, 4, v2
    v_lshlrev_b32 v15, 4, v2
    v_mov_b32 v12, 0x8888
    v_bfe_u32 v60, v1, 3, 2
    v_bfe_u32 v61, v1, 2, 1
    v_lshrrev_b32 v62, 5, v1
    v_and_b32 v2, 1, v60
    v_lshlrev_b32 v2, 4, v2
    v_lshlrev_b32 v2, v2, s46
    v_lshrrev_b32 v60, 1, v60
    v_lshl_add_u32 v3, v61, 1, v60
    v_sub_u32 v63, v63, v62
    v_lshl_add_u32 v3, v63, 1, v3
    v_and_b32 v63, 1, v63
    v_lshl_or_b32 v3, v63, 4, v3
    v_xor_b32 v61, v61, v62
    v_lshl_or_b32 v60, v61, 4, v60
    v_cmp_eq_u32 s[48:49], 0, v3
    v_cmp_eq_u32 s[50:51], 1, v3
    v_cmp_eq_u32 s[52:53], 2, v3
    v_cmp_eq_u32 vcc, 3, v3
    v_cndmask_b32 v4, 0, v2, s[48:49]
    v_cndmask_b32 v5, 0, v2, s[50:51]
    v_cndmask_b32 v6, 0, v2, s[52:53]
    v_cndmask_b32 v7, 0, v2, vcc
    v_cmp_eq_u32 s[48:49], 4, v3
    v_cmp_eq_u32 s[50:51], 5, v3
    v_cmp_eq_u32 s[52:53], 6, v3
    v_cmp_eq_u32 vcc, 7, v3
    v_cndmask_b32 v8, 0, v2, s[48:49]
    v_cndmask_b32 v9, 0, v2, s[50:51]
    v_cndmask_b32 v10, 0, v2, s[52:53]
    v_cndmask_b32 v11, 0, v2, vcc
    v_cmp_eq_u32 s[48:49], 0, v60
    v_cmp_eq_u32 s[50:51], 1, v60
    v_and_b32 v63, 3, v1
    v_lshlrev_b32 v61, 3, v63
    v_cndmask_b32 v16, 0, v2, s[48:49]
    v_cndmask_b32 v17, 0, v2, s[50:51]
    v_add_u32 v13, 11552, v61
    s_lshl_b32 s30, s3, 9
    s_sub_u32 s31, s30, 4096
    s_max_i32 s31, s31, 0
    s_add_u32 s30, s30, s31
    s_add_u32 s30, s30, 2048
    v_lshrrev_b32 v2, 4, v1
    v_lshl_add_u32 v22, v2, 4, s30
    v_bfe_u32 v3, v1, 2, 2
    v_lshl_add_u32 v23, v3, 4, s30
    v_lshl_add_u32 v23, v2, 2, v23
    s_lshl_b32 s30, s3, 2
    s_add_u32 s30, s30, 32
    v_add_u32 v2, s30, v2
    v_mul_u32_u24 v68, 648, v2
    v_add_u32 v68, v68, v20
    v_add_u32 v68, 55040, v68
    s_mul_i32 s30, s23, 20480
    s_lshl_b32 s31, s22, 7
    s_add_u32 s30, s30, s31
    v_lshl_add_u32 v69, v2, 8, v20
    v_add_u32 v69, s30, v69
    s_waitcnt lgkmcnt(0)
    v_lshlrev_b32 v60, 16, v64
    v_lshlrev_b32 v61, 16, v65
    v_lshlrev_b32 v62, 16, v66
    v_lshlrev_b32 v63, 16, v67
    v_mul_f32 v60, s40, v60
    v_mul_f32 v61, s40, v61
    v_mul_f32 v62, s40, v62
    v_mul_f32 v63, s40, v63
    v_cvt_pk_bf16_f32 v18, v60, v61
    v_cvt_pk_bf16_f32 v19, v62, v63
L_b4:
    s_setprio 3
    s_mul_i32 s30, s22, 2560000
    s_add_u32 s36, s20, s30
    s_addc_u32 s37, s21, 0
    s_mov_b32 s38, 2560000
    s_mov_b32 s39, 0x20000
    s_mov_b32 s44, 128
    s_mov_b32 s45, 128
    ds_read_b128 v[24:27], v22
    ds_read_b64 v[40:41], v22 offset:64
    ds_read_b64 v[28:29], v22 offset:72
    ds_read_b32 v34, v23
    s_waitcnt lgkmcnt(0)
    v_lshl_add_u64 v[40:41], v[40:41], 0, v[20:21]
    v_lshl_add_u32 v34, v34, 1, v13
    s_barrier
    s_cmp_lg_u32 s25, 0
    s_cbranch_scc1 L_safe
    ds_read_b128 v[44:47], v24
    ds_read_b128 v[48:51], v25
    ds_read_b64 v[32:33], v40 offset:512
    ds_read_b64 v[30:31], v34
    s_lshr_b32 s30, s3, 2
    s_cmp_lg_u32 s30, 1
    s_cbranch_scc1 L_nopoll
    s_mov_b64 exec, s[66:67]
    s_cbranch_execz L_p2e
    s_mov_b32 s31, 200000
L_p2:
    global_load_dwordx2 v[66:67], v64, s[20:21] sc1
    s_sub_u32 s31, s31, 1
    s_cbranch_scc1 L_p2d
    s_waitcnt vmcnt(0)
    v_cmp_ne_u64 vcc, s[26:27], v[66:67]
    s_and_b64 exec, exec, vcc
    s_cbranch_scc0 L_p2d
    s_branch L_p2
L_p2d:
    s_cmp_lg_u32 s73, 0
    s_cbranch_scc1 L_grb
    s_bfm_b64 exec, 32, 0
    global_load_dword v35, v65, s[20:21] sc1
L_grb:
    s_mov_b64 exec, 1
    v_mov_b32 v2, 0
    v_mov_b32 v3, 1
    ds_add_u32 v2, v3 offset:1560
L_p2e:
    s_mov_b64 exec, -1
L_nopoll:
    s_cmp_lt_u32 s3, 8
    s_cbranch_scc1 L_nobuild
    v_lshlrev_b32 v2, 3, v1
    v_mov_b32 v3, 0
    ds_read_b64 v[72:73], v2 offset:0
    ds_read_b32 v79, v3 offset:1548
    v_mul_u32_u24 v74, 544, v1
    v_add_u32 v74, 10336, v74
    v_add_u32 v75, 272, v74
    v_mul_u32_u24 v82, 1296, v1
    s_and_b32 s32, s3, 1
    s_mul_i32 s30, s32, 648
    s_add_u32 s30, s30, 75776
    v_add_u32 v82, s30, v82
    v_mov_b32 v83, v82
    s_mul_i32 s30, s32, 272
    v_add_u32 v80, s30, v74
    v_add_u32 v81, 16, v80
    s_waitcnt lgkmcnt(0)
    v_sub_u32 v72, v72, v74 clamp
    v_sub_u32 v73, v73, v75 clamp
    v_max_u32 v76, v72, v73
    v_cmp_lt_u32 vcc, 160, v76
    v_cmp_ne_u32 s[48:49], 0, v79
    v_add_u32 v74, 12, v72
    v_add_u32 v75, 12, v73
    s_or_b64 vcc, vcc, s[48:49]
    s_cbranch_scc1 L_bad
    v_add_u32 v72, 28, v72
    v_add_u32 v73, 28, v73
    v_lshrrev_b32 v74, 5, v74
    v_lshrrev_b32 v75, 5, v75
    v_lshrrev_b32 v72, 5, v72
    v_lshrrev_b32 v73, 5, v73
    v_sub_u32 v72, v72, v74
    v_sub_u32 v73, v73, v75
    v_lshl_or_b32 v72, v72, 16, v74
    v_lshl_or_b32 v73, v73, 16, v75
    v_add_u32 v76, v72, v73
    v_add_u32 v77, v72, v73
    s_nop 1
    v_add_u32_dpp v77, v77, v77 row_shr:1 row_mask:0xf bank_mask:0xf bound_ctrl:0
    s_nop 1
    v_add_u32_dpp v77, v77, v77 row_shr:2 row_mask:0xf bank_mask:0xf bound_ctrl:0
    s_nop 1
    v_add_u32_dpp v77, v77, v77 row_shr:4 row_mask:0xf bank_mask:0xf bound_ctrl:0
    s_nop 1
    v_add_u32_dpp v77, v77, v77 row_shr:8 row_mask:0xf bank_mask:0xf bound_ctrl:0
    s_nop 1
    v_add_u32_dpp v77, v77, v77 row_bcast:15 row_mask:0xa bank_mask:0xf
    s_nop 1
    v_add_u32_dpp v77, v77, v77 row_bcast:31 row_mask:0xc bank_mask:0xf
    s_cmp_eq_u32 s32, 0
    s_cselect_b64 vcc, -1, 0
    v_readlane_b32 s30, v77, 63
    v_cndmask_b32 v76, v73, v76, vcc
    v_cndmask_b32 v72, v73, v72, vcc
    v_sub_u32 v77, v77, v76
    s_and_b32 s50, s30, 0xffff
    s_add_u32 s31, s50, 3
    s_lshr_b32 s31, s31, 2
    s_sub_u32 s51, 0, s50
    s_and_b32 s51, s51, 3
    s_lshr_b32 s30, s30, 16
    s_add_u32 s30, s30, 3
    s_sub_u32 s30, s30, s51
    s_lshr_b32 s30, s30, 2
    s_lshl_b32 s33, s31, 1
    s_add_u32 s33, s33, s30
    s_cmp_gt_u32 s33, 104
    s_cbranch_scc1 L_bad
    s_lshl_b32 s30, s30, 8
    s_or_b32 s29, s30, s31
    v_and_b32 v74, 0xffff, v72
    v_and_b32 v76, 0xffff, v77
    s_mov_b32 s34, 6144
    s_mov_b32 s35, 2184
    s_cmp_lt_u32 s3, 10
    s_cbranch_scc1 L_brem
L_bf:
    v_cmp_ne_u32 vcc, 0, v74
    s_and_b64 exec, exec, vcc
    s_cbranch_execz L_bfd
    v_subrev_u32 v78, 32, v76
    v_bfe_u32 v79, v76, 2, 2
    v_lshl_add_u32 v79, v79, 10, s34
    v_lshrrev_b32 v84, 5, v78
    v_lshl_add_u32 v79, v84, 7, v79
    v_bfe_u32 v84, v78, 4, 1
    v_lshl_add_u32 v79, v84, 3, v79
    v_lshrrev_b32 v84, 2, v76
    v_cmp_gt_u32 vcc, 32, v76
    v_lshl_add_u32 v84, v84, 9, s35
    v_and_b32 v78, 3, v76
    v_cndmask_b32 v79, v79, v84, vcc
    v_lshl_add_u32 v79, v78, 4, v79
    ds_write_b64 v79, v[80:81]
    ds_write_b64 v79, v[82:83] offset:64
    v_add_u32 v80, 32, v80
    v_add_u32 v81, 32, v81
    v_add_u32 v76, 1, v76
    v_subrev_u32 v74, 1, v74
    s_branch L_bf
L_brem:
    v_lshl_add_u32 v80, v74, 5, v80
    v_add_u32 v81, 16, v80
    v_lshrrev_b32 v77, 16, v77
    s_sub_u32 s52, 0, s31
    s_and_b32 s52, s52, 3
    s_add_u32 s53, s31, s52
    s_lshl_b32 s52, s52, 3
    v_subrev_u32 v73, s51, v77
    v_subrev_u32 v74, s52, v73
    v_lshrrev_b32 v76, 3, v73
    v_add_u32 v76, s31, v76
    v_and_b32 v75, 4, v73
    v_lshrrev_b32 v78, 5, v74
    v_lshl_add_u32 v78, v78, 2, s53
    v_bfe_u32 v79, v74, 2, 2
    v_add_u32 v78, v78, v79
    v_cmp_gt_u32 vcc, s52, v73
    v_lshrrev_b32 v74, 2, v74
    v_and_b32 v74, 4, v74
    v_cndmask_b32 v76, v78, v76, vcc
    v_cndmask_b32 v75, v74, v75, vcc
    v_and_b32 v78, 3, v73
    v_cmp_gt_u32 s[54:55], s51, v77
    v_lshl_add_u32 v76, v76, 2, v78
    v_add_u32 v78, s50, v77
    v_cndmask_b32 v76, v76, v78, s[54:55]
    v_subrev_u32 v78, 32, v76
    v_bfe_u32 v79, v76, 2, 2
    v_lshl_add_u32 v79, v79, 10, s34
    v_lshrrev_b32 v84, 5, v78
    v_lshl_add_u32 v79, v84, 7, v79
    v_bfe_u32 v84, v78, 4, 1
    v_lshl_add_u32 v79, v84, 3, v79
    v_lshrrev_b32 v84, 2, v76
    v_cmp_gt_u32 vcc, 32, v76
    v_lshl_add_u32 v84, v84, 9, s35
    v_and_b32 v78, 3, v76
    v_cndmask_b32 v79, v79, v84, vcc
    v_lshl_add_u32 v79, v78, 4, v79
    v_cmp_lt_u32 vcc, 0xffff, v72
    v_add_u32 v75, v79, v75
    s_andn2_b64 exec, vcc, s[54:55]
    ds_write2_b32 v75, v80, v82 offset0:0 offset1:16
    s_and_b64 exec, vcc, s[54:55]
    ds_write_b64 v79, v[80:81]
    ds_write_b64 v79, v[82:83] offset:64
L_bfd:
    s_mov_b64 exec, -1
    s_mov_b32 s56, s29
    s_cmp_eq_u32 s3, 8
    s_cselect_b32 s29, s29, 0
    s_add_u32 s29, s29, 0x10000
    s_branch L_built
L_bad:
    s_mov_b32 s56, 0
    s_mov_b32 s29, 0x1010000
L_built:
    v_mov_b32 v2, s29
    s_mov_b64 exec, 1
    ds_add_u32 v3, v2 offset:1552
    s_add_u32 s30, s24, s3
    s_cmp_lg_u32 s30, 8
    s_cbranch_scc1 L_notw
    v_mov_b32 v2, s26
    v_mov_b32 v3, 10223616
    global_store_dword v3, v2, s[20:21] sc1
L_notw:
    s_mov_b64 exec, -1
    v_mov_b32 v2, 0
    s_mov_b32 s30, s56
    s_and_b32 s31, s30, 0xff
    s_bfe_u32 s30, s30, 0x80008
    s_and_b32 s28, s3, 3
    s_sub_u32 s32, 0, s31
    s_and_b32 s32, s32, 3
    s_add_u32 s33, s28, s32
    s_sub_i32 s33, s33, 4
    s_lshl_b32 s29, s33, 1
    s_sub_i32 s29, s30, s29
    s_max_i32 s29, s29, 0
    s_min_i32 s29, s29, 2
    s_cmp_lt_i32 s33, 0
    s_cselect_b32 s29, 0, s29
    s_lshl_b32 s32, s32, 1
    s_sub_i32 s30, s30, s32
    s_sub_i32 s30, s30, s28
    s_add_i32 s30, s30, 3
    s_max_i32 s30, s30, 0
    s_lshr_b32 s30, s30, 2
    s_add_u32 s30, s30, s29
    s_sub_u32 s32, s31, s28
    s_add_u32 s32, s32, 3
    s_lshr_b32 s32, s32, 2
    s_lshl_b32 s32, s32, 1
    s_add_u32 s30, s30, s32
    s_sub_i32 s30, s30, 4
    s_max_i32 s30, s30, 0
    s_add_u32 s70, s30, 6
    s_sub_i32 s31, s31, s3
    s_add_i32 s31, s31, 3
    s_max_i32 s31, s31, 0
    s_lshr_b32 s31, s31, 2
    s_lshl_b32 s31, s31, 1
    s_lshl_b32 s31, -1, s31
    s_or_b32 s31, s31, 0x55555555
    s_lshl_b32 s32, 2, s30
    s_sub_u32 s32, s32, 1
    s_and_b32 s31, s31, s32
    s_lshl_b32 s32, 64, s30
    s_or_b32 s71, s31, s32
    v_and_b32 v72, 15, v1
    v_lshrrev_b32 v73, 4, v1
    s_lshl_b32 s31, s3, 2
    s_add_u32 s31, s31, 32
    v_add_u32 v73, s31, v73
    v_mul_u32_u24 v74, 272, v73
    v_lshl_add_u32 v74, v72, 4, v74
    v_add_u32 v74, 10240, v74
    v_mul_u32_u24 v75, 648, v73
    v_add_u32 v75, 75776, v75
    v_cmp_gt_u32 vcc, 6, v72
    v_add_u32 v72, s30, v72
    v_lshrrev_b32 v73, 2, v72
    v_lshl_add_u32 v73, v73, 7, v22
    v_and_b32 v72, 3, v72
    v_lshl_add_u32 v73, v72, 2, v73
    s_mov_b64 exec, vcc
    ds_write2_b32 v73, v74, v75 offset0:0 offset1:16
    s_cmp_lg_u32 s30, 0
    s_cbranch_scc1 L_cw2
    v_mov_b32 v3, 1
    s_mov_b64 exec, 1
    ds_add_u32 v2, v3 offset:1568
L_cw2:
    s_mov_b64 exec, -1
    s_mov_b32 s31, 4000000
L_wnc:
    ds_read_b32 v3, v2 offset:1552
    s_sub_u32 s31, s31, 1
    s_cbranch_scc1 L_gosafe
    s_waitcnt lgkmcnt(0)
    v_readfirstlane_b32 s30, v3
    s_bitcmp1_b32 s30, 18
    s_cbranch_scc0 L_wnc
    s_cmp_gt_u32 s30, 16777215
    s_cbranch_scc1 L_gosafe
    ds_read_b128 v[24:27], v22
    ds_read_b64 v[40:41], v22 offset:64
    ds_read_b64 v[28:29], v22 offset:72
    ds_read_b32 v34, v23
    s_waitcnt lgkmcnt(0)
    v_lshl_add_u64 v[40:41], v[40:41], 0, v[20:21]
    v_lshl_add_u32 v34, v34, 1, v13
    ds_read_b128 v[44:47], v24
    ds_read_b128 v[48:51], v25
    ds_read_b64 v[32:33], v40 offset:512
    ds_read_b64 v[30:31], v34
L_nobuild:
    s_waitcnt lgkmcnt(0)
    v_mfma_f32_32x32x8_bf16 v[72:87], v[16:17], v[32:33], 0
    v_lshl_add_u64 v[44:45], v[44:45], 0, v[14:15]
    v_lshl_add_u64 v[46:47], v[46:47], 0, v[14:15]
    v_lshl_add_u64 v[48:49], v[48:49], 0, v[14:15]
    v_lshl_add_u64 v[50:51], v[50:51], 0, v[14:15]
    v_mfma_f32_16x16x4_4b_bf16 v[72:87], v[30:31], v[18:19], v[72:87] cbsz:2 abid:0
    ds_read_b64 v[32:33], v41 offset:512
    v_mov_b32 v2, 0
    s_mov_b32 s31, 4000000
L_w_gok:
L_wf_gok:
    ds_read_b32 v3, v2 offset:1560
    s_sub_u32 s31, s31, 1
    s_cbranch_scc1 L_wd_gok
    s_waitcnt lgkmcnt(0)
    v_readfirstlane_b32 s30, v3
    s_and_b32 s30, s30, 255
    s_cmp_lg_u32 s30, 4
    s_cbranch_scc1 L_w_gok
L_wd_gok:
    buffer_load_dwordx4 v[104:107], v44, s[36:39], 0 offen sc1
    buffer_load_dwordx4 v[108:111], v45, s[36:39], 0 offen sc1
    buffer_load_dwordx4 v[112:115], v46, s[36:39], 0 offen sc1
    buffer_load_dwordx4 v[116:119], v47, s[36:39], 0 offen sc1
    buffer_load_dwordx4 v[120:123], v48, s[36:39], 0 offen sc1
    buffer_load_dwordx4 v[124:127], v49, s[36:39], 0 offen sc1
    buffer_load_dwordx4 v[128:131], v50, s[36:39], 0 offen sc1
    buffer_load_dwordx4 v[132:135], v51, s[36:39], 0 offen sc1
    s_mov_b32 s31, 4000000
    s_cmp_ge_u32 s3, 8
    s_cbranch_scc1 L_nd
L_wna:
    ds_read_b32 v3, v2 offset:1552
    s_sub_u32 s31, s31, 1
    s_cbranch_scc1 L_gosafe
    s_waitcnt lgkmcnt(0)
    v_readfirstlane_b32 s30, v3
    s_bitcmp1_b32 s30, 18
    s_cbranch_scc0 L_wna
    s_cmp_gt_u32 s30, 16777215
    s_cbranch_scc1 L_gosafe
    s_and_b32 s31, s30, 0xff
    s_mov_b32 s70, 14
    s_cmp_ge_u32 s3, s31
    s_cselect_b32 s30, 0x80, 0
    s_or_b32 s71, s30, 0x4141
L_nd:
    s_waitcnt vmcnt(6)
    v_smfmac_f32_32x32x32_bf16 v[72:87], v[4:7], v[104:111], v12
    s_waitcnt vmcnt(4)
    v_smfmac_f32_32x32x32_bf16 v[72:87], v[8:11], v[112:119], v12
    v_mov_b32 v3, 1
    s_nop 7
    s_mov_b32 s72, 76
    s_setprio 3
L_L0:
    v_mfma_f32_32x32x8_bf16 v[88:103], v[16:17], v[32:33], 0
    v_exp_f32 v44, v72
    v_exp_f32 v45, v76
    v_exp_f32 v46, v80
    v_exp_f32 v47, v84
    v_mfma_f32_16x16x4_4b_bf16 v[88:103], v[30:31], v[18:19], v[88:103] cbsz:2 abid:1
    v_exp_f32 v48, v73
    v_exp_f32 v49, v77
    v_exp_f32 v50, v81
    v_exp_f32 v51, v85
    s_bitcmp1_b32 s71, 0
    s_cbranch_scc1 L_L0f
    v_pk_fma_f32 v[52:53], v[52:53], v[44:45], v[52:53]
    s_waitcnt lgkmcnt(0)
    v_lshl_add_u64 v[42:43], v[28:29], 0, v[20:21]
    v_pk_fma_f32 v[54:55], v[54:55], v[46:47], v[54:55]
    ds_read_b128 v[36:39], v26
    v_pk_fma_f32 v[52:53], v[104:105], v[56:57], v[52:53]
    ds_read_b64 v[32:33], v42 offset:512
    v_pk_fma_f32 v[54:55], v[106:107], v[58:59], v[54:55]
    v_pk_fma_f32 v[56:57], v[56:57], v[44:45], v[56:57]
    v_pk_fma_f32 v[58:59], v[58:59], v[46:47], v[58:59]
    v_pk_fma_f32 v[52:53], v[52:53], v[48:49], v[52:53]
    v_pk_fma_f32 v[54:55], v[54:55], v[50:51], v[54:55]
    v_pk_fma_f32 v[52:53], v[108:109], v[56:57], v[52:53]
    v_pk_fma_f32 v[54:55], v[110:111], v[58:59], v[54:55]
    v_pk_fma_f32 v[56:57], v[56:57], v[48:49], v[56:57]
    v_pk_fma_f32 v[58:59], v[58:59], v[50:51], v[58:59]
L_L0r:
    s_waitcnt vmcnt(2)
    v_smfmac_f32_32x32x32_bf16 v[88:103], v[4:7], v[120:127], v12
    v_exp_f32 v44, v74
    v_exp_f32 v45, v78
    v_exp_f32 v46, v82
    v_exp_f32 v47, v86
    s_waitcnt vmcnt(0)
    v_smfmac_f32_32x32x32_bf16 v[88:103], v[8:11], v[128:135], v12
    v_exp_f32 v48, v75
    v_exp_f32 v49, v79
    v_exp_f32 v50, v83
    v_exp_f32 v51, v87
    v_pk_fma_f32 v[52:53], v[52:53], v[44:45], v[52:53]
    s_waitcnt lgkmcnt(0)
    v_lshl_add_u64 v[36:37], v[36:37], 0, v[14:15]
    v_pk_fma_f32 v[54:55], v[54:55], v[46:47], v[54:55]
    buffer_load_dwordx4 v[136:139], v36, s[36:39], 0 offen sc1
    v_pk_fma_f32 v[52:53], v[112:113], v[56:57], v[52:53]
    v_lshl_add_u64 v[38:39], v[38:39], 0, v[14:15]
    v_pk_fma_f32 v[54:55], v[114:115], v[58:59], v[54:55]
    buffer_load_dwordx4 v[140:143], v37, s[36:39], 0 offen sc1
    v_pk_fma_f32 v[56:57], v[56:57], v[44:45], v[56:57]
    v_pk_fma_f32 v[58:59], v[58:59], v[46:47], v[58:59]
    buffer_load_dwordx4 v[144:147], v38, s[36:39], 0 offen sc1
    v_pk_fma_f32 v[52:53], v[52:53], v[48:49], v[52:53]
    v_pk_fma_f32 v[54:55], v[54:55], v[50:51], v[54:55]
    s_sub_u32 s70, s70, 1
    buffer_load_dwordx4 v[148:151], v39, s[36:39], 0 offen sc1
    v_pk_fma_f32 v[52:53], v[116:117], v[56:57], v[52:53]
    v_pk_fma_f32 v[54:55], v[118:119], v[58:59], v[54:55]
    v_pk_fma_f32 v[56:57], v[56:57], v[48:49], v[56:57]
    s_lshr_b32 s71, s71, 1
    v_pk_fma_f32 v[58:59], v[58:59], v[50:51], v[58:59]
    s_bitcmp1_b32 s71, 0
    s_cbranch_scc1 L_L0z
L_L0y:
    s_bitcmp1_b32 s72, s70
    s_cbranch_scc1 L_L0q
L_L0p:
    s_cmp_le_u32 s70, 2
    s_cbranch_scc1 L_T1
L_L1:
    v_mfma_f32_32x32x8_bf16 v[72:87], v[16:17], v[32:33], 0
    v_exp_f32 v44, v88
    v_exp_f32 v45, v92
    v_exp_f32 v46, v96
    v_exp_f32 v47, v100
    v_mfma_f32_16x16x4_4b_bf16 v[72:87], v[30:31], v[18:19], v[72:87] cbsz:2 abid:2
    v_exp_f32 v48, v89
    v_exp_f32 v49, v93
    v_exp_f32 v50, v97
    v_exp_f32 v51, v101
    s_bitcmp1_b32 s71, 0
    s_cbranch_scc1 L_L1f
    v_pk_fma_f32 v[52:53], v[52:53], v[44:45], v[52:53]
    s_waitcnt lgkmcnt(0)
    v_pk_fma_f32 v[54:55], v[54:55], v[46:47], v[54:55]
    ds_read_b128 v[36:39], v27
    v_pk_fma_f32 v[52:53], v[120:121], v[56:57], v[52:53]
    ds_read_b64 v[32:33], v43 offset:512
    v_pk_fma_f32 v[54:55], v[122:123], v[58:59], v[54:55]
    v_pk_fma_f32 v[56:57], v[56:57], v[44:45], v[56:57]
    v_pk_fma_f32 v[58:59], v[58:59], v[46:47], v[58:59]
    v_pk_fma_f32 v[52:53], v[52:53], v[48:49], v[52:53]
    v_pk_fma_f32 v[54:55], v[54:55], v[50:51], v[54:55]
    v_pk_fma_f32 v[52:53], v[124:125], v[56:57], v[52:53]
    v_pk_fma_f32 v[54:55], v[126:127], v[58:59], v[54:55]
    v_pk_fma_f32 v[56:57], v[56:57], v[48:49], v[56:57]
    v_pk_fma_f32 v[58:59], v[58:59], v[50:51], v[58:59]
L_L1r:
    s_waitcnt vmcnt(2)
    v_smfmac_f32_32x32x32_bf16 v[72:87], v[4:7], v[136:143], v12
    v_exp_f32 v44, v90
    v_exp_f32 v45, v94
    v_exp_f32 v46, v98
    v_exp_f32 v47, v102
    s_waitcnt vmcnt(0)
    v_smfmac_f32_32x32x32_bf16 v[72:87], v[8:11], v[144:151], v12
    v_exp_f32 v48, v91
    v_exp_f32 v49, v95
    v_exp_f32 v50, v99
    v_exp_f32 v51, v103
    v_pk_fma_f32 v[52:53], v[52:53], v[44:45], v[52:53]
    s_waitcnt lgkmcnt(0)
    v_lshl_add_u64 v[36:37], v[36:37], 0, v[14:15]
    v_pk_fma_f32 v[54:55], v[54:55], v[46:47], v[54:55]
    buffer_load_dwordx4 v[152:155], v36, s[36:39], 0 offen sc1
    v_pk_fma_f32 v[52:53], v[128:129], v[56:57], v[52:53]
    v_lshl_add_u64 v[38:39], v[38:39], 0, v[14:15]
    v_pk_fma_f32 v[54:55], v[130:131], v[58:59], v[54:55]
    buffer_load_dwordx4 v[156:159], v37, s[36:39], 0 offen sc1
    v_pk_fma_f32 v[56:57], v[56:57], v[44:45], v[56:57]
    ds_read_b64 v[28:29], v22 offset:192
    v_pk_fma_f32 v[58:59], v[58:59], v[46:47], v[58:59]
    buffer_load_dwordx4 v[160:163], v38, s[36:39], 0 offen sc1
    v_pk_fma_f32 v[52:53], v[52:53], v[48:49], v[52:53]
    ds_read_b32 v34, v23 offset:128
    ds_read_b128 v[24:27], v22 offset:128
    v_pk_fma_f32 v[54:55], v[54:55], v[50:51], v[54:55]
    s_sub_u32 s70, s70, 1
    buffer_load_dwordx4 v[164:167], v39, s[36:39], 0 offen sc1
    v_pk_fma_f32 v[52:53], v[132:133], v[56:57], v[52:53]
    v_pk_fma_f32 v[54:55], v[134:135], v[58:59], v[54:55]
    v_pk_fma_f32 v[56:57], v[56:57], v[48:49], v[56:57]
    s_lshr_b32 s71, s71, 1
    v_pk_fma_f32 v[58:59], v[58:59], v[50:51], v[58:59]
    s_bitcmp1_b32 s71, 0
    s_cbranch_scc1 L_L1z
L_L1y:
    s_bitcmp1_b32 s72, s70
    s_cbranch_scc1 L_L1q
L_L1p:
    s_cmp_le_u32 s70, 2
    s_cbranch_scc1 L_T2
L_L2:
    v_mfma_f32_32x32x8_bf16 v[88:103], v[16:17], v[32:33], 0
    v_exp_f32 v44, v72
    v_exp_f32 v45, v76
    v_exp_f32 v46, v80
    v_exp_f32 v47, v84
    v_mfma_f32_16x16x4_4b_bf16 v[88:103], v[30:31], v[18:19], v[88:103] cbsz:2 abid:3
    v_exp_f32 v48, v73
    v_exp_f32 v49, v77
    v_exp_f32 v50, v81
    v_exp_f32 v51, v85
    s_bitcmp1_b32 s71, 0
    s_cbranch_scc1 L_L2f
    v_pk_fma_f32 v[52:53], v[52:53], v[44:45], v[52:53]
    s_waitcnt lgkmcnt(0)
    v_lshl_add_u64 v[40:41], v[28:29], 0, v[20:21]
    v_pk_fma_f32 v[54:55], v[54:55], v[46:47], v[54:55]
    ds_read_b128 v[36:39], v24
    v_pk_fma_f32 v[52:53], v[136:137], v[56:57], v[52:53]
    ds_read_b64 v[32:33], v40 offset:512
    v_pk_fma_f32 v[54:55], v[138:139], v[58:59], v[54:55]
    v_pk_fma_f32 v[56:57], v[56:57], v[44:45], v[56:57]
    v_lshl_add_u32 v34, v34, 1, v13
    v_pk_fma_f32 v[58:59], v[58:59], v[46:47], v[58:59]
    v_pk_fma_f32 v[52:53], v[52:53], v[48:49], v[52:53]
    v_pk_fma_f32 v[54:55], v[54:55], v[50:51], v[54:55]
    ds_read_b64 v[30:31], v34
    v_pk_fma_f32 v[52:53], v[140:141], v[56:57], v[52:53]
    v_pk_fma_f32 v[54:55], v[142:143], v[58:59], v[54:55]
    v_pk_fma_f32 v[56:57], v[56:57], v[48:49], v[56:57]
    v_pk_fma_f32 v[58:59], v[58:59], v[50:51], v[58:59]
L_L2r:
    s_waitcnt vmcnt(2)
    v_smfmac_f32_32x32x32_bf16 v[88:103], v[4:7], v[152:159], v12
    v_exp_f32 v44, v74
    v_exp_f32 v45, v78
    v_exp_f32 v46, v82
    v_exp_f32 v47, v86
    s_waitcnt vmcnt(0)
    v_smfmac_f32_32x32x32_bf16 v[88:103], v[8:11], v[160:167], v12
    v_exp_f32 v48, v75
    v_exp_f32 v49, v79
    v_exp_f32 v50, v83
    v_exp_f32 v51, v87
    v_pk_fma_f32 v[52:53], v[52:53], v[44:45], v[52:53]
    s_waitcnt lgkmcnt(0)
    v_lshl_add_u64 v[36:37], v[36:37], 0, v[14:15]
    v_pk_fma_f32 v[54:55], v[54:55], v[46:47], v[54:55]
    buffer_load_dwordx4 v[104:107], v36, s[36:39], 0 offen sc1
    v_pk_fma_f32 v[52:53], v[144:145], v[56:57], v[52:53]
    v_lshl_add_u64 v[38:39], v[38:39], 0, v[14:15]
    v_pk_fma_f32 v[54:55], v[146:147], v[58:59], v[54:55]
    buffer_load_dwordx4 v[108:111], v37, s[36:39], 0 offen sc1
    v_pk_fma_f32 v[56:57], v[56:57], v[44:45], v[56:57]
    v_pk_fma_f32 v[58:59], v[58:59], v[46:47], v[58:59]
    buffer_load_dwordx4 v[112:115], v38, s[36:39], 0 offen sc1
    v_pk_fma_f32 v[52:53], v[52:53], v[48:49], v[52:53]
    v_pk_fma_f32 v[54:55], v[54:55], v[50:51], v[54:55]
    s_sub_u32 s70, s70, 1
    buffer_load_dwordx4 v[116:119], v39, s[36:39], 0 offen sc1
    v_pk_fma_f32 v[52:53], v[148:149], v[56:57], v[52:53]
    v_pk_fma_f32 v[54:55], v[150:151], v[58:59], v[54:55]
    v_pk_fma_f32 v[56:57], v[56:57], v[48:49], v[56:57]
    s_lshr_b32 s71, s71, 1
    v_pk_fma_f32 v[58:59], v[58:59], v[50:51], v[58:59]
    s_bitcmp1_b32 s71, 0
    s_cbranch_scc1 L_L2z
L_L2y:
    s_bitcmp1_b32 s72, s70
    s_cbranch_scc1 L_L2q
L_L2p:
    s_cmp_le_u32 s70, 2
    s_cbranch_scc1 L_T3
L_L3:
    v_mfma_f32_32x32x8_bf16 v[72:87], v[16:17], v[32:33], 0
    v_exp_f32 v44, v88
    v_exp_f32 v45, v92
    v_exp_f32 v46, v96
    v_exp_f32 v47, v100
    v_mfma_f32_16x16x4_4b_bf16 v[72:87], v[30:31], v[18:19], v[72:87] cbsz:2 abid:0
    v_exp_f32 v48, v89
    v_exp_f32 v49, v93
    v_exp_f32 v50, v97
    v_exp_f32 v51, v101
    s_bitcmp1_b32 s71, 0
    s_cbranch_scc1 L_L3f
    v_pk_fma_f32 v[52:53], v[52:53], v[44:45], v[52:53]
    s_waitcnt lgkmcnt(0)
    v_pk_fma_f32 v[54:55], v[54:55], v[46:47], v[54:55]
    ds_read_b128 v[36:39], v25
    v_pk_fma_f32 v[52:53], v[152:153], v[56:57], v[52:53]
    ds_read_b64 v[32:33], v41 offset:512
    v_pk_fma_f32 v[54:55], v[154:155], v[58:59], v[54:55]
    v_pk_fma_f32 v[56:57], v[56:57], v[44:45], v[56:57]
    v_pk_fma_f32 v[58:59], v[58:59], v[46:47], v[58:59]
    v_pk_fma_f32 v[52:53], v[52:53], v[48:49], v[52:53]
    v_pk_fma_f32 v[54:55], v[54:55], v[50:51], v[54:55]
    v_pk_fma_f32 v[52:53], v[156:157], v[56:57], v[52:53]
    v_pk_fma_f32 v[54:55], v[158:159], v[58:59], v[54:55]
    v_pk_fma_f32 v[56:57], v[56:57], v[48:49], v[56:57]
    v_pk_fma_f32 v[58:59], v[58:59], v[50:51], v[58:59]
L_L3r:
    s_waitcnt vmcnt(2)
    v_smfmac_f32_32x32x32_bf16 v[72:87], v[4:7], v[104:111], v12
    v_exp_f32 v44, v90
    v_exp_f32 v45, v94
    v_exp_f32 v46, v98
    v_exp_f32 v47, v102
    s_waitcnt vmcnt(0)
    v_smfmac_f32_32x32x32_bf16 v[72:87], v[8:11], v[112:119], v12
    v_exp_f32 v48, v91
    v_exp_f32 v49, v95
    v_exp_f32 v50, v99
    v_exp_f32 v51, v103
    v_pk_fma_f32 v[52:53], v[52:53], v[44:45], v[52:53]
    s_waitcnt lgkmcnt(0)
    v_lshl_add_u64 v[36:37], v[36:37], 0, v[14:15]
    v_pk_fma_f32 v[54:55], v[54:55], v[46:47], v[54:55]
    buffer_load_dwordx4 v[120:123], v36, s[36:39], 0 offen sc1
    v_pk_fma_f32 v[52:53], v[160:161], v[56:57], v[52:53]
    v_lshl_add_u64 v[38:39], v[38:39], 0, v[14:15]
    v_pk_fma_f32 v[54:55], v[162:163], v[58:59], v[54:55]
    buffer_load_dwordx4 v[124:127], v37, s[36:39], 0 offen sc1
    v_pk_fma_f32 v[56:57], v[56:57], v[44:45], v[56:57]
    ds_read_b64 v[28:29], v22 offset:200
    v_pk_fma_f32 v[58:59], v[58:59], v[46:47], v[58:59]
    buffer_load_dwordx4 v[128:131], v38, s[36:39], 0 offen sc1
    v_pk_fma_f32 v[52:53], v[52:53], v[48:49], v[52:53]
    v_pk_fma_f32 v[54:55], v[54:55], v[50:51], v[54:55]
    s_sub_u32 s70, s70, 1
    buffer_load_dwordx4 v[132:135], v39, s[36:39], 0 offen sc1
    v_pk_fma_f32 v[52:53], v[164:165], v[56:57], v[52:53]
    v_lshl_add_u64 v[22:23], v[22:23], 0, s[44:45]
    v_pk_fma_f32 v[54:55], v[166:167], v[58:59], v[54:55]
    v_pk_fma_f32 v[56:57], v[56:57], v[48:49], v[56:57]
    s_lshr_b32 s71, s71, 1
    v_pk_fma_f32 v[58:59], v[58:59], v[50:51], v[58:59]
    s_bitcmp1_b32 s71, 0
    s_cbranch_scc1 L_L3z
L_L3y:
    s_bitcmp1_b32 s72, s70
    s_cbranch_scc1 L_L3q
L_L3p:
    s_cmp_le_u32 s70, 2
    s_cbranch_scc0 L_L0
L_T0:
    v_mfma_f32_32x32x8_bf16 v[88:103], v[16:17], v[32:33], 0
    v_exp_f32 v44, v72
    v_exp_f32 v45, v76
    v_exp_f32 v46, v80
    v_exp_f32 v47, v84
    v_mfma_f32_16x16x4_4b_bf16 v[88:103], v[30:31], v[18:19], v[88:103] cbsz:2 abid:1
    v_exp_f32 v48, v73
    v_exp_f32 v49, v77
    v_exp_f32 v50, v81
    v_exp_f32 v51, v85
    ds_read_b32 v3, v2 offset:1568
    v_pk_fma_f32 v[52:53], v[52:53], v[44:45], v[52:53]
    v_pk_fma_f32 v[54:55], v[54:55], v[46:47], v[54:55]
    ds_read_b64 v[60:61], v68 offset:20736
    v_pk_fma_f32 v[52:53], v[104:105], v[56:57], v[52:53]
    v_pk_fma_f32 v[54:55], v[106:107], v[58:59], v[54:55]
    ds_read_b64 v[62:63], v68 offset:20864
    v_pk_fma_f32 v[56:57], v[56:57], v[44:45], v[56:57]
    v_pk_fma_f32 v[58:59], v[58:59], v[46:47], v[58:59]
    ds_read_b64 v[64:65], v68 offset:20992
    v_pk_fma_f32 v[52:53], v[52:53], v[48:49], v[52:53]
    v_pk_fma_f32 v[54:55], v[54:55], v[50:51], v[54:55]
    ds_read_b64 v[66:67], v68 offset:21120
    v_pk_fma_f32 v[52:53], v[108:109], v[56:57], v[52:53]
    v_pk_fma_f32 v[54:55], v[110:111], v[58:59], v[54:55]
    v_pk_fma_f32 v[56:57], v[56:57], v[48:49], v[56:57]
    v_pk_fma_f32 v[58:59], v[58:59], v[50:51], v[58:59]
    s_waitcnt vmcnt(2)
    v_smfmac_f32_32x32x32_bf16 v[88:103], v[4:7], v[120:127], v12
    v_exp_f32 v44, v74
    v_exp_f32 v45, v78
    v_exp_f32 v46, v82
    v_exp_f32 v47, v86
    s_waitcnt vmcnt(0)
    v_smfmac_f32_32x32x32_bf16 v[88:103], v[8:11], v[128:135], v12
    v_exp_f32 v48, v75
    v_exp_f32 v49, v79
    v_exp_f32 v50, v83
    v_exp_f32 v51, v87
    v_pk_fma_f32 v[52:53], v[52:53], v[44:45], v[52:53]
    v_pk_fma_f32 v[54:55], v[54:55], v[46:47], v[54:55]
    v_pk_fma_f32 v[52:53], v[112:113], v[56:57], v[52:53]
    v_pk_fma_f32 v[54:55], v[114:115], v[58:59], v[54:55]
    v_pk_fma_f32 v[56:57], v[56:57], v[44:45], v[56:57]
    v_pk_fma_f32 v[58:59], v[58:59], v[46:47], v[58:59]
    v_pk_fma_f32 v[52:53], v[52:53], v[48:49], v[52:53]
    v_pk_fma_f32 v[54:55], v[54:55], v[50:51], v[54:55]
    v_pk_fma_f32 v[52:53], v[116:117], v[56:57], v[52:53]
    v_pk_fma_f32 v[54:55], v[118:119], v[58:59], v[54:55]
    v_pk_fma_f32 v[56:57], v[56:57], v[48:49], v[56:57]
    v_pk_fma_f32 v[58:59], v[58:59], v[50:51], v[58:59]
    v_exp_f32 v44, v88
    v_exp_f32 v45, v92
    v_exp_f32 v46, v96
    v_exp_f32 v47, v100
    v_exp_f32 v48, v89
    v_exp_f32 v49, v93
    v_exp_f32 v50, v97
    v_exp_f32 v51, v101
    v_pk_fma_f32 v[52:53], v[52:53], v[44:45], v[52:53]
    v_pk_fma_f32 v[54:55], v[54:55], v[46:47], v[54:55]
    v_pk_fma_f32 v[52:53], v[120:121], v[56:57], v[52:53]
    v_pk_fma_f32 v[54:55], v[122:123], v[58:59], v[54:55]
    v_pk_fma_f32 v[56:57], v[56:57], v[44:45], v[56:57]
    v_pk_fma_f32 v[58:59], v[58:59], v[46:47], v[58:59]
    v_pk_fma_f32 v[52:53], v[52:53], v[48:49], v[52:53]
    v_pk_fma_f32 v[54:55], v[54:55], v[50:51], v[54:55]
    v_pk_fma_f32 v[52:53], v[124:125], v[56:57], v[52:53]
    v_pk_fma_f32 v[54:55], v[126:127], v[58:59], v[54:55]
    v_pk_fma_f32 v[56:57], v[56:57], v[48:49], v[56:57]
    v_pk_fma_f32 v[58:59], v[58:59], v[50:51], v[58:59]
    v_exp_f32 v44, v90
    v_exp_f32 v45, v94
    v_exp_f32 v46, v98
    v_exp_f32 v47, v102
    v_exp_f32 v48, v91
    v_exp_f32 v49, v95
    v_exp_f32 v50, v99
    v_exp_f32 v51, v103
    v_pk_fma_f32 v[52:53], v[52:53], v[44:45], v[52:53]
    v_pk_fma_f32 v[54:55], v[54:55], v[46:47], v[54:55]
    v_pk_fma_f32 v[52:53], v[128:129], v[56:57], v[52:53]
    v_pk_fma_f32 v[54:55], v[130:131], v[58:59], v[54:55]
    v_pk_fma_f32 v[56:57], v[56:57], v[44:45], v[56:57]
    v_pk_fma_f32 v[58:59], v[58:59], v[46:47], v[58:59]
    v_pk_fma_f32 v[52:53], v[52:53], v[48:49], v[52:53]
    v_pk_fma_f32 v[54:55], v[54:55], v[50:51], v[54:55]
    v_pk_fma_f32 v[52:53], v[132:133], v[56:57], v[52:53]
    v_pk_fma_f32 v[54:55], v[134:135], v[58:59], v[54:55]
    v_pk_fma_f32 v[56:57], v[56:57], v[48:49], v[56:57]
    v_pk_fma_f32 v[58:59], v[58:59], v[50:51], v[58:59]
L_mdone:
    s_mov_b32 s32, 0x4f800000
    s_mov_b32 s34, 0xafb8aa3b
    s_mov_b32 s31, 4000000
    v_rcp_f32 v56, v56
    v_rcp_f32 v57, v57
    v_rcp_f32 v58, v58
    v_rcp_f32 v59, v59
L_dw:
    s_waitcnt lgkmcnt(0)
    v_readfirstlane_b32 s30, v3
    s_add_u32 s30, s30, s25
    s_cmp_lt_u32 s30, 12
    s_cbranch_scc1 L_dr
L_dx:
    s_cmp_ge_u32 s3, 8
    s_cbranch_scc1 L_d1
    ds_read_b64 v[12:13], v68 offset:0
    ds_read_b64 v[14:15], v68 offset:128
    ds_read_b64 v[16:17], v68 offset:256
    ds_read_b64 v[18:19], v68 offset:384
L_d1:
    v_cvt_f32_f64 v28, v[60:61]
    v_cvt_f32_f64 v29, v[62:63]
    v_cvt_f32_f64 v30, v[64:65]
    v_cvt_f32_f64 v31, v[66:67]
    v_pk_fma_f32 v[28:29], v[52:53], v[56:57], v[28:29]
    v_pk_fma_f32 v[30:31], v[54:55], v[58:59], v[30:31]
    v_pk_mul_f32 v[36:37], v[28:29], s[34:35] op_sel_hi:[1,0]
    v_pk_mul_f32 v[38:39], v[30:31], s[34:35] op_sel_hi:[1,0]
    v_exp_f32 v36, v36
    v_exp_f32 v37, v37
    v_exp_f32 v38, v38
    v_exp_f32 v39, v39
    v_pk_add_f32 v[10:11], v[28:29], v[30:31]
    v_pk_fma_f32 v[36:37], v[36:37], s[32:33], s[32:33] op_sel_hi:[1,0,0]
    v_pk_fma_f32 v[38:39], v[38:39], s[32:33], s[32:33] op_sel_hi:[1,0,0]
    v_rcp_f32 v36, v36
    v_rcp_f32 v37, v37
    v_rcp_f32 v38, v38
    v_rcp_f32 v39, v39
    v_mov_b32 v9, 0x207
    v_pk_mul_f32 v[36:37], v[28:29], v[36:37]
    v_pk_mul_f32 v[38:39], v[30:31], v[38:39]
    v_cvt_pk_bf16_f32 v44, v36, v37
    v_cvt_pk_bf16_f32 v45, v38, v39
    global_store_dwordx2 v69, v[44:45], s[18:19] sc1
    s_cmp_ge_u32 s3, 8
    s_cbranch_scc1 L_e4
    v_subrev_u32 v69, 8192, v69
    s_waitcnt lgkmcnt(0)
    v_cvt_f32_f64 v28, v[12:13]
    v_cvt_f32_f64 v29, v[14:15]
    v_cvt_f32_f64 v30, v[16:17]
    v_cvt_f32_f64 v31, v[18:19]
    v_pk_mul_f32 v[36:37], v[28:29], s[34:35] op_sel_hi:[1,0]
    v_pk_mul_f32 v[38:39], v[30:31], s[34:35] op_sel_hi:[1,0]
    v_exp_f32 v36, v36
    v_exp_f32 v37, v37
    v_exp_f32 v38, v38
    v_exp_f32 v39, v39
    v_pk_add_f32 v[10:11], v[10:11], v[28:29]
    v_pk_fma_f32 v[36:37], v[36:37], s[32:33], s[32:33] op_sel_hi:[1,0,0]
    v_pk_fma_f32 v[38:39], v[38:39], s[32:33], s[32:33] op_sel_hi:[1,0,0]
    v_rcp_f32 v36, v36
    v_rcp_f32 v37, v37
    v_rcp_f32 v38, v38
    v_rcp_f32 v39, v39
    v_pk_add_f32 v[10:11], v[10:11], v[30:31]
    v_pk_mul_f32 v[36:37], v[28:29], v[36:37]
    v_pk_mul_f32 v[38:39], v[30:31], v[38:39]
    v_cvt_pk_bf16_f32 v46, v36, v37
    v_cvt_pk_bf16_f32 v47, v38, v39
    global_store_dwordx2 v69, v[46:47], s[18:19] sc1
L_e4:
    v_add_f32 v10, v10, v11
    v_cmp_class_f32 vcc, v10, v9
    v_mov_b32 v2, 0
    s_cmp_lg_u32 s25, 0
    s_cbranch_scc1 L_fin
    s_cbranch_vccz L_e5
    ds_write_b32 v2, v9 offset:1548
    s_waitcnt lgkmcnt(0)
L_e5:
    s_barrier
    ds_read_b32 v2, v2 offset:1548
    s_waitcnt lgkmcnt(0)
    v_readfirstlane_b32 s30, v2
    s_cmp_lg_u32 s30, 0
    s_cbranch_scc1 L_gosafe
L_fin:
L_end:
    s_endpgm
L_gosafe:
    s_mov_b32 s25, 16
    s_setprio 0
    s_waitcnt vmcnt(0) lgkmcnt(0)
    s_barrier
    s_branch L_restart
L_xa0:
    s_waitcnt vmcnt(3)
    v_add_co_u32_dpp v2, vcc, v164, v158 row_newbcast:0 row_mask:0xf bank_mask:0xf
    s_mov_b64 exec, vcc
    v_add3_u32 v163, v163, v105, v106
    v_add_u32 v163, v163, v107
    s_mov_b64 exec, -1
    v_add_co_u32_dpp v2, vcc, v164, v158 row_newbcast:1 row_mask:0xf bank_mask:0xf
    s_mov_b64 exec, vcc
    v_add3_u32 v163, v163, v109, v110
    v_add_u32 v163, v163, v111
    s_mov_b64 exec, -1
    v_add_co_u32_dpp v2, vcc, v164, v158 row_newbcast:2 row_mask:0xf bank_mask:0xf
    s_mov_b64 exec, vcc
    v_add3_u32 v163, v163, v113, v114
    v_add_u32 v163, v163, v115
    s_mov_b64 exec, -1
    s_branch L_xb0
L_rt0:
    s_sub_u32 s34, s34, 1
    s_cbranch_scc1 L_toobig
    s_and_b32 s30, s68, 7
    s_cbranch_scc0 L_nxr0_
    s_bitcmp1_b32 s68, 0
    s_cbranch_scc0 L_nxr0_0
    v_add_co_u32_dpp v2, vcc, v164, v158 row_newbcast:0 row_mask:0xf bank_mask:0xf
    s_mov_b64 exec, vcc
    global_load_dwordx4 v[104:107], v136, s[20:21] offset:192 sc1
    s_mov_b64 exec, -1
L_nxr0_0:
    s_bitcmp1_b32 s68, 1
    s_cbranch_scc0 L_nxr0_1
    v_add_co_u32_dpp v2, vcc, v164, v158 row_newbcast:1 row_mask:0xf bank_mask:0xf
    s_mov_b64 exec, vcc
    global_load_dwordx4 v[108:111], v137, s[20:21] offset:192 sc1
    s_mov_b64 exec, -1
L_nxr0_1:
    s_bitcmp1_b32 s68, 2
    s_cbranch_scc0 L_nxr0_2
    v_add_co_u32_dpp v2, vcc, v164, v158 row_newbcast:2 row_mask:0xf bank_mask:0xf
    s_mov_b64 exec, vcc
    global_load_dwordx4 v[112:115], v138, s[20:21] offset:192 sc1
    s_mov_b64 exec, -1
L_nxr0_2:
L_nxr0_:
    s_mov_b64 exec, s[48:49]
    global_load_dwordx4 v[72:75], v136, s[20:21] sc1
    s_mov_b64 exec, s[50:51]
    global_load_dwordx4 v[76:79], v137, s[20:21] sc1
    s_mov_b64 exec, s[52:53]
    global_load_dwordx4 v[80:83], v138, s[20:21] sc1
    s_mov_b64 exec, -1
    s_waitcnt vmcnt(0)
    s_branch L_ck0
L_ya0:
    s_bitcmp1_b32 s68, 0
    s_cbranch_scc0 L_yn0
    s_mov_b64 exec, -1
    v_add_co_u32_dpp v2, vcc, v164, v158 row_newbcast:0 row_mask:0xf bank_mask:0xf
    s_mov_b64 exec, vcc
    v_mul_u32_u24_sdwa v104, v161, v105 dst_sel:DWORD dst_unused:UNUSED_PAD src0_sel:DWORD src1_sel:BYTE_3
    v_and_b32 v105, 4194048, v105
    ds_add_rtn_u32 v104, v104, v161 offset:0
    s_waitcnt lgkmcnt(0)
    s_mov_b64 exec, vcc
    v_lshlrev_b32 v2, 1, v104
    ds_write_b32 v104, v105
    ds_write_b64 v2, v[106:107] offset:11552
L_yn0:
    s_bitcmp1_b32 s68, 1
    s_cbranch_scc0 L_yn1
    s_mov_b64 exec, -1
    v_add_co_u32_dpp v2, vcc, v164, v158 row_newbcast:1 row_mask:0xf bank_mask:0xf
    s_mov_b64 exec, vcc
    v_mul_u32_u24_sdwa v108, v161, v109 dst_sel:DWORD dst_unused:UNUSED_PAD src0_sel:DWORD src1_sel:BYTE_3
    v_and_b32 v109, 4194048, v109
    ds_add_rtn_u32 v108, v108, v161 offset:0
    s_waitcnt lgkmcnt(0)
    s_mov_b64 exec, vcc
    v_lshlrev_b32 v2, 1, v108
    ds_write_b32 v108, v109
    ds_write_b64 v2, v[110:111] offset:11552
L_yn1:
    s_bitcmp1_b32 s68, 2
    s_cbranch_scc0 L_yn2
    s_mov_b64 exec, -1
    v_add_co_u32_dpp v2, vcc, v164, v158 row_newbcast:2 row_mask:0xf bank_mask:0xf
    s_mov_b64 exec, vcc
    v_mul_u32_u24_sdwa v112, v161, v113 dst_sel:DWORD dst_unused:UNUSED_PAD src0_sel:DWORD src1_sel:BYTE_3
    v_and_b32 v113, 4194048, v113
    ds_add_rtn_u32 v112, v112, v161 offset:0
    s_waitcnt lgkmcnt(0)
    s_mov_b64 exec, vcc
    v_lshlrev_b32 v2, 1, v112
    ds_write_b32 v112, v113
    ds_write_b64 v2, v[114:115] offset:11552
L_yn2:
    s_branch L_yb0
L_xa1:
    s_waitcnt vmcnt(5)
    v_add_co_u32_dpp v2, vcc, v164, v158 row_newbcast:3 row_mask:0xf bank_mask:0xf
    s_mov_b64 exec, vcc
    v_add3_u32 v163, v163, v117, v118
    v_add_u32 v163, v163, v119
    s_mov_b64 exec, -1
    v_add_co_u32_dpp v2, vcc, v164, v158 row_newbcast:4 row_mask:0xf bank_mask:0xf
    s_mov_b64 exec, vcc
    v_add3_u32 v163, v163, v121, v122
    v_add_u32 v163, v163, v123
    s_mov_b64 exec, -1
    v_add_co_u32_dpp v2, vcc, v164, v158 row_newbcast:5 row_mask:0xf bank_mask:0xf
    s_mov_b64 exec, vcc
    v_add3_u32 v163, v163, v125, v126
    v_add_u32 v163, v163, v127
    s_mov_b64 exec, -1
    s_branch L_xb1
L_rt1:
    s_sub_u32 s34, s34, 1
    s_cbranch_scc1 L_toobig
    s_and_b32 s30, s68, 56
    s_cbranch_scc0 L_nxr1_
    s_bitcmp1_b32 s68, 3
    s_cbranch_scc0 L_nxr1_3
    v_add_co_u32_dpp v2, vcc, v164, v158 row_newbcast:3 row_mask:0xf bank_mask:0xf
    s_mov_b64 exec, vcc
    global_load_dwordx4 v[116:119], v139, s[20:21] offset:192 sc1
    s_mov_b64 exec, -1
L_nxr1_3:
    s_bitcmp1_b32 s68, 4
    s_cbranch_scc0 L_nxr1_4
    v_add_co_u32_dpp v2, vcc, v164, v158 row_newbcast:4 row_mask:0xf bank_mask:0xf
    s_mov_b64 exec, vcc
    global_load_dwordx4 v[120:123], v140, s[20:21] offset:192 sc1
    s_mov_b64 exec, -1
L_nxr1_4:
    s_bitcmp1_b32 s68, 5
    s_cbranch_scc0 L_nxr1_5
    v_add_co_u32_dpp v2, vcc, v164, v158 row_newbcast:5 row_mask:0xf bank_mask:0xf
    s_mov_b64 exec, vcc
    global_load_dwordx4 v[124:127], v141, s[20:21] offset:192 sc1
    s_mov_b64 exec, -1
L_nxr1_5:
L_nxr1_:
    s_mov_b64 exec, s[54:55]
    global_load_dwordx4 v[84:87], v139, s[20:21] sc1
    s_mov_b64 exec, s[56:57]
    global_load_dwordx4 v[88:91], v140, s[20:21] sc1
    s_mov_b64 exec, s[58:59]
    global_load_dwordx4 v[92:95], v141, s[20:21] sc1
    s_mov_b64 exec, -1
    s_waitcnt vmcnt(0)
    s_branch L_ck1
L_ya1:
    s_bitcmp1_b32 s68, 3
    s_cbranch_scc0 L_yn3
    s_mov_b64 exec, -1
    v_add_co_u32_dpp v2, vcc, v164, v158 row_newbcast:3 row_mask:0xf bank_mask:0xf
    s_mov_b64 exec, vcc
    v_mul_u32_u24_sdwa v116, v161, v117 dst_sel:DWORD dst_unused:UNUSED_PAD src0_sel:DWORD src1_sel:BYTE_3
    v_and_b32 v117, 4194048, v117
    ds_add_rtn_u32 v116, v116, v161 offset:0
    s_waitcnt lgkmcnt(0)
    s_mov_b64 exec, vcc
    v_lshlrev_b32 v2, 1, v116
    ds_write_b32 v116, v117
    ds_write_b64 v2, v[118:119] offset:11552
L_yn3:
    s_bitcmp1_b32 s68, 4
    s_cbranch_scc0 L_yn4
    s_mov_b64 exec, -1
    v_add_co_u32_dpp v2, vcc, v164, v158 row_newbcast:4 row_mask:0xf bank_mask:0xf
    s_mov_b64 exec, vcc
    v_mul_u32_u24_sdwa v120, v161, v121 dst_sel:DWORD dst_unused:UNUSED_PAD src0_sel:DWORD src1_sel:BYTE_3
    v_and_b32 v121, 4194048, v121
    ds_add_rtn_u32 v120, v120, v161 offset:0
    s_waitcnt lgkmcnt(0)
    s_mov_b64 exec, vcc
    v_lshlrev_b32 v2, 1, v120
    ds_write_b32 v120, v121
    ds_write_b64 v2, v[122:123] offset:11552
L_yn4:
    s_bitcmp1_b32 s68, 5
    s_cbranch_scc0 L_yn5
    s_mov_b64 exec, -1
    v_add_co_u32_dpp v2, vcc, v164, v158 row_newbcast:5 row_mask:0xf bank_mask:0xf
    s_mov_b64 exec, vcc
    v_mul_u32_u24_sdwa v124, v161, v125 dst_sel:DWORD dst_unused:UNUSED_PAD src0_sel:DWORD src1_sel:BYTE_3
    v_and_b32 v125, 4194048, v125
    ds_add_rtn_u32 v124, v124, v161 offset:0
    s_waitcnt lgkmcnt(0)
    s_mov_b64 exec, vcc
    v_lshlrev_b32 v2, 1, v124
    ds_write_b32 v124, v125
    ds_write_b64 v2, v[126:127] offset:11552
L_yn5:
    s_branch L_yb1
L_xa2:
    s_waitcnt vmcnt(5)
    v_add_co_u32_dpp v2, vcc, v164, v158 row_newbcast:6 row_mask:0xf bank_mask:0xf
    s_mov_b64 exec, vcc
    v_add3_u32 v163, v163, v129, v130
    v_add_u32 v163, v163, v131
    s_mov_b64 exec, -1
    v_add_co_u32_dpp v2, vcc, v164, v158 row_newbcast:7 row_mask:0xf bank_mask:0xf
    s_mov_b64 exec, vcc
    v_add3_u32 v163, v163, v133, v134
    v_add_u32 v163, v163, v135
    s_mov_b64 exec, -1
    s_branch L_xb2
L_rt2:
    s_sub_u32 s34, s34, 1
    s_cbranch_scc1 L_giveup
    s_and_b32 s30, s68, 192
    s_cbranch_scc0 L_nxr2_
    s_bitcmp1_b32 s68, 6
    s_cbranch_scc0 L_nxr2_6
    v_add_co_u32_dpp v2, vcc, v164, v158 row_newbcast:6 row_mask:0xf bank_mask:0xf
    s_mov_b64 exec, vcc
    global_load_dwordx4 v[128:131], v142, s[20:21] offset:192 sc1
    s_mov_b64 exec, -1
L_nxr2_6:
    s_bitcmp1_b32 s68, 7
    s_cbranch_scc0 L_nxr2_7
    v_add_co_u32_dpp v2, vcc, v164, v158 row_newbcast:7 row_mask:0xf bank_mask:0xf
    s_mov_b64 exec, vcc
    global_load_dwordx4 v[132:135], v143, s[20:21] offset:192 sc1
    s_mov_b64 exec, -1
L_nxr2_7:
L_nxr2_:
    s_mov_b64 exec, s[60:61]
    global_load_dwordx4 v[96:99], v142, s[20:21] sc1
    s_mov_b64 exec, s[62:63]
    global_load_dwordx4 v[100:103], v143, s[20:21] sc1
    s_mov_b64 exec, -1
    s_waitcnt vmcnt(0)
    s_branch L_ck2
L_ya2:
    s_bitcmp1_b32 s68, 6
    s_cbranch_scc0 L_yn6
    s_mov_b64 exec, -1
    v_add_co_u32_dpp v2, vcc, v164, v158 row_newbcast:6 row_mask:0xf bank_mask:0xf
    s_mov_b64 exec, vcc
    v_mul_u32_u24_sdwa v128, v161, v129 dst_sel:DWORD dst_unused:UNUSED_PAD src0_sel:DWORD src1_sel:BYTE_3
    v_and_b32 v129, 4194048, v129
    ds_add_rtn_u32 v128, v128, v161 offset:0
    s_waitcnt lgkmcnt(0)
    s_mov_b64 exec, vcc
    v_lshlrev_b32 v2, 1, v128
    ds_write_b32 v128, v129
    ds_write_b64 v2, v[130:131] offset:11552
L_yn6:
    s_bitcmp1_b32 s68, 7
    s_cbranch_scc0 L_yn7
    s_mov_b64 exec, -1
    v_add_co_u32_dpp v2, vcc, v164, v158 row_newbcast:7 row_mask:0xf bank_mask:0xf
    s_mov_b64 exec, vcc
    v_mul_u32_u24_sdwa v132, v161, v133 dst_sel:DWORD dst_unused:UNUSED_PAD src0_sel:DWORD src1_sel:BYTE_3
    v_and_b32 v133, 4194048, v133
    ds_add_rtn_u32 v132, v132, v161 offset:0
    s_waitcnt lgkmcnt(0)
    s_mov_b64 exec, vcc
    v_lshlrev_b32 v2, 1, v132
    ds_write_b32 v132, v133
    ds_write_b64 v2, v[134:135] offset:11552
L_yn7:
    s_branch L_yb2
L_L0f:
    v_pk_add_f32 v[56:57], v[44:45], 1.0 op_sel_hi:[1,0]
    s_waitcnt lgkmcnt(0)
    v_lshl_add_u64 v[42:43], v[28:29], 0, v[20:21]
    v_pk_add_f32 v[58:59], v[46:47], 1.0 op_sel_hi:[1,0]
    ds_read_b128 v[36:39], v26
    v_pk_fma_f32 v[52:53], v[104:105], v[48:49], v[104:105]
    ds_read_b64 v[32:33], v42 offset:512
    v_pk_fma_f32 v[54:55], v[106:107], v[50:51], v[106:107]
    v_pk_fma_f32 v[52:53], v[108:109], v[56:57], v[52:53]
    v_pk_fma_f32 v[54:55], v[110:111], v[58:59], v[54:55]
    v_pk_fma_f32 v[56:57], v[56:57], v[48:49], v[56:57]
    v_pk_fma_f32 v[58:59], v[58:59], v[50:51], v[58:59]
    s_branch L_L0r
L_L0z:
    v_rcp_f32 v56, v56
    v_rcp_f32 v57, v57
    v_rcp_f32 v58, v58
    v_rcp_f32 v59, v59
    v_pk_mul_f32 v[52:53], v[52:53], v[56:57]
    v_pk_mul_f32 v[54:55], v[54:55], v[58:59]
    v_cvt_f64_f32 v[60:61], v52
    v_cvt_f64_f32 v[62:63], v53
    ds_add_f64 v40, v[60:61] offset:0
    v_cvt_f64_f32 v[64:65], v54
    ds_add_f64 v40, v[62:63] offset:128
    v_cvt_f64_f32 v[66:67], v55
    ds_add_f64 v40, v[64:65] offset:256
    ds_add_f64 v40, v[66:67] offset:384
    s_branch L_L0y
L_L0q:
    s_setprio 0
    s_cmp_le_u32 s70, 2
    s_cbranch_scc1 L_L0p
    s_setprio 1
    s_cmp_le_u32 s70, 3
    s_cbranch_scc1 L_L0p
    s_setprio 2
    s_mov_b64 exec, 1
    ds_add_u32 v2, v3 offset:1568
    s_mov_b64 exec, -1
    s_branch L_L0p
L_L1f:
    v_pk_add_f32 v[56:57], v[44:45], 1.0 op_sel_hi:[1,0]
    s_waitcnt lgkmcnt(0)
    v_pk_add_f32 v[58:59], v[46:47], 1.0 op_sel_hi:[1,0]
    ds_read_b128 v[36:39], v27
    v_pk_fma_f32 v[52:53], v[120:121], v[48:49], v[120:121]
    ds_read_b64 v[32:33], v43 offset:512
    v_pk_fma_f32 v[54:55], v[122:123], v[50:51], v[122:123]
    v_pk_fma_f32 v[52:53], v[124:125], v[56:57], v[52:53]
    v_pk_fma_f32 v[54:55], v[126:127], v[58:59], v[54:55]
    v_pk_fma_f32 v[56:57], v[56:57], v[48:49], v[56:57]
    v_pk_fma_f32 v[58:59], v[58:59], v[50:51], v[58:59]
    s_branch L_L1r
L_L1z:
    v_rcp_f32 v56, v56
    v_rcp_f32 v57, v57
    v_rcp_f32 v58, v58
    v_rcp_f32 v59, v59
    v_pk_mul_f32 v[52:53], v[52:53], v[56:57]
    v_pk_mul_f32 v[54:55], v[54:55], v[58:59]
    v_cvt_f64_f32 v[60:61], v52
    v_cvt_f64_f32 v[62:63], v53
    ds_add_f64 v41, v[60:61] offset:0
    v_cvt_f64_f32 v[64:65], v54
    ds_add_f64 v41, v[62:63] offset:128
    v_cvt_f64_f32 v[66:67], v55
    ds_add_f64 v41, v[64:65] offset:256
    ds_add_f64 v41, v[66:67] offset:384
    s_branch L_L1y
L_L1q:
    s_setprio 0
    s_cmp_le_u32 s70, 2
    s_cbranch_scc1 L_L1p
    s_setprio 1
    s_cmp_le_u32 s70, 3
    s_cbranch_scc1 L_L1p
    s_setprio 2
    s_mov_b64 exec, 1
    ds_add_u32 v2, v3 offset:1568
    s_mov_b64 exec, -1
    s_branch L_L1p
L_L2f:
    v_pk_add_f32 v[56:57], v[44:45], 1.0 op_sel_hi:[1,0]
    s_waitcnt lgkmcnt(0)
    v_lshl_add_u64 v[40:41], v[28:29], 0, v[20:21]
    v_pk_add_f32 v[58:59], v[46:47], 1.0 op_sel_hi:[1,0]
    ds_read_b128 v[36:39], v24
    v_pk_fma_f32 v[52:53], v[136:137], v[48:49], v[136:137]
    ds_read_b64 v[32:33], v40 offset:512
    v_pk_fma_f32 v[54:55], v[138:139], v[50:51], v[138:139]
    v_pk_fma_f32 v[52:53], v[140:141], v[56:57], v[52:53]
    v_lshl_add_u32 v34, v34, 1, v13
    v_pk_fma_f32 v[54:55], v[142:143], v[58:59], v[54:55]
    v_pk_fma_f32 v[56:57], v[56:57], v[48:49], v[56:57]
    v_pk_fma_f32 v[58:59], v[58:59], v[50:51], v[58:59]
    ds_read_b64 v[30:31], v34
    s_branch L_L2r
L_L2z:
    v_rcp_f32 v56, v56
    v_rcp_f32 v57, v57
    v_rcp_f32 v58, v58
    v_rcp_f32 v59, v59
    v_pk_mul_f32 v[52:53], v[52:53], v[56:57]
    v_pk_mul_f32 v[54:55], v[54:55], v[58:59]
    v_cvt_f64_f32 v[60:61], v52
    v_cvt_f64_f32 v[62:63], v53
    ds_add_f64 v42, v[60:61] offset:0
    v_cvt_f64_f32 v[64:65], v54
    ds_add_f64 v42, v[62:63] offset:128
    v_cvt_f64_f32 v[66:67], v55
    ds_add_f64 v42, v[64:65] offset:256
    ds_add_f64 v42, v[66:67] offset:384
    s_branch L_L2y
L_L2q:
    s_setprio 0
    s_cmp_le_u32 s70, 2
    s_cbranch_scc1 L_L2p
    s_setprio 1
    s_cmp_le_u32 s70, 3
    s_cbranch_scc1 L_L2p
    s_setprio 2
    s_mov_b64 exec, 1
    ds_add_u32 v2, v3 offset:1568
    s_mov_b64 exec, -1
    s_branch L_L2p
L_L3f:
    v_pk_add_f32 v[56:57], v[44:45], 1.0 op_sel_hi:[1,0]
    s_waitcnt lgkmcnt(0)
    v_pk_add_f32 v[58:59], v[46:47], 1.0 op_sel_hi:[1,0]
    ds_read_b128 v[36:39], v25
    v_pk_fma_f32 v[52:53], v[152:153], v[48:49], v[152:153]
    ds_read_b64 v[32:33], v41 offset:512
    v_pk_fma_f32 v[54:55], v[154:155], v[50:51], v[154:155]
    v_pk_fma_f32 v[52:53], v[156:157], v[56:57], v[52:53]
    v_pk_fma_f32 v[54:55], v[158:159], v[58:59], v[54:55]
    v_pk_fma_f32 v[56:57], v[56:57], v[48:49], v[56:57]
    v_pk_fma_f32 v[58:59], v[58:59], v[50:51], v[58:59]
    s_branch L_L3r
L_L3z:
    v_rcp_f32 v56, v56
    v_rcp_f32 v57, v57
    v_rcp_f32 v58, v58
    v_rcp_f32 v59, v59
    v_pk_mul_f32 v[52:53], v[52:53], v[56:57]
    v_pk_mul_f32 v[54:55], v[54:55], v[58:59]
    v_cvt_f64_f32 v[60:61], v52
    v_cvt_f64_f32 v[62:63], v53
    ds_add_f64 v43, v[60:61] offset:0
    v_cvt_f64_f32 v[64:65], v54
    ds_add_f64 v43, v[62:63] offset:128
    v_cvt_f64_f32 v[66:67], v55
    ds_add_f64 v43, v[64:65] offset:256
    ds_add_f64 v43, v[66:67] offset:384
    s_branch L_L3y
L_L3q:
    s_setprio 0
    s_cmp_le_u32 s70, 2
    s_cbranch_scc1 L_L3p
    s_setprio 1
    s_cmp_le_u32 s70, 3
    s_cbranch_scc1 L_L3p
    s_setprio 2
    s_mov_b64 exec, 1
    ds_add_u32 v2, v3 offset:1568
    s_mov_b64 exec, -1
    s_branch L_L3p
L_T1:
    v_mfma_f32_32x32x8_bf16 v[72:87], v[16:17], v[32:33], 0
    v_exp_f32 v44, v88
    v_exp_f32 v45, v92
    v_exp_f32 v46, v96
    v_exp_f32 v47, v100
    v_mfma_f32_16x16x4_4b_bf16 v[72:87], v[30:31], v[18:19], v[72:87] cbsz:2 abid:2
    v_exp_f32 v48, v89
    v_exp_f32 v49, v93
    v_exp_f32 v50, v97
    v_exp_f32 v51, v101
    ds_read_b32 v3, v2 offset:1568
    v_pk_fma_f32 v[52:53], v[52:53], v[44:45], v[52:53]
    v_pk_fma_f32 v[54:55], v[54:55], v[46:47], v[54:55]
    ds_read_b64 v[60:61], v68 offset:20736
    v_pk_fma_f32 v[52:53], v[120:121], v[56:57], v[52:53]
    v_pk_fma_f32 v[54:55], v[122:123], v[58:59], v[54:55]
    ds_read_b64 v[62:63], v68 offset:20864
    v_pk_fma_f32 v[56:57], v[56:57], v[44:45], v[56:57]
    v_pk_fma_f32 v[58:59], v[58:59], v[46:47], v[58:59]
    ds_read_b64 v[64:65], v68 offset:20992
    v_pk_fma_f32 v[52:53], v[52:53], v[48:49], v[52:53]
    v_pk_fma_f32 v[54:55], v[54:55], v[50:51], v[54:55]
    ds_read_b64 v[66:67], v68 offset:21120
    v_pk_fma_f32 v[52:53], v[124:125], v[56:57], v[52:53]
    v_pk_fma_f32 v[54:55], v[126:127], v[58:59], v[54:55]
    v_pk_fma_f32 v[56:57], v[56:57], v[48:49], v[56:57]
    v_pk_fma_f32 v[58:59], v[58:59], v[50:51], v[58:59]
    s_waitcnt vmcnt(2)
    v_smfmac_f32_32x32x32_bf16 v[72:87], v[4:7], v[136:143], v12
    v_exp_f32 v44, v90
    v_exp_f32 v45, v94
    v_exp_f32 v46, v98
    v_exp_f32 v47, v102
    s_waitcnt vmcnt(0)
    v_smfmac_f32_32x32x32_bf16 v[72:87], v[8:11], v[144:151], v12
    v_exp_f32 v48, v91
    v_exp_f32 v49, v95
    v_exp_f32 v50, v99
    v_exp_f32 v51, v103
    v_pk_fma_f32 v[52:53], v[52:53], v[44:45], v[52:53]
    v_pk_fma_f32 v[54:55], v[54:55], v[46:47], v[54:55]
    v_pk_fma_f32 v[52:53], v[128:129], v[56:57], v[52:53]
    v_pk_fma_f32 v[54:55], v[130:131], v[58:59], v[54:55]
    v_pk_fma_f32 v[56:57], v[56:57], v[44:45], v[56:57]
    v_pk_fma_f32 v[58:59], v[58:59], v[46:47], v[58:59]
    v_pk_fma_f32 v[52:53], v[52:53], v[48:49], v[52:53]
    v_pk_fma_f32 v[54:55], v[54:55], v[50:51], v[54:55]
    v_pk_fma_f32 v[52:53], v[132:133], v[56:57], v[52:53]
    v_pk_fma_f32 v[54:55], v[134:135], v[58:59], v[54:55]
    v_pk_fma_f32 v[56:57], v[56:57], v[48:49], v[56:57]
    v_pk_fma_f32 v[58:59], v[58:59], v[50:51], v[58:59]
    v_exp_f32 v44, v72
    v_exp_f32 v45, v76
    v_exp_f32 v46, v80
    v_exp_f32 v47, v84
    v_exp_f32 v48, v73
    v_exp_f32 v49, v77
    v_exp_f32 v50, v81
    v_exp_f32 v51, v85
    v_pk_fma_f32 v[52:53], v[52:53], v[44:45], v[52:53]
    v_pk_fma_f32 v[54:55], v[54:55], v[46:47], v[54:55]
    v_pk_fma_f32 v[52:53], v[136:137], v[56:57], v[52:53]
    v_pk_fma_f32 v[54:55], v[138:139], v[58:59], v[54:55]
    v_pk_fma_f32 v[56:57], v[56:57], v[44:45], v[56:57]
    v_pk_fma_f32 v[58:59], v[58:59], v[46:47], v[58:59]
    v_pk_fma_f32 v[52:53], v[52:53], v[48:49], v[52:53]
    v_pk_fma_f32 v[54:55], v[54:55], v[50:51], v[54:55]
    v_pk_fma_f32 v[52:53], v[140:141], v[56:57], v[52:53]
    v_pk_fma_f32 v[54:55], v[142:143], v[58:59], v[54:55]
    v_pk_fma_f32 v[56:57], v[56:57], v[48:49], v[56:57]
    v_pk_fma_f32 v[58:59], v[58:59], v[50:51], v[58:59]
    v_exp_f32 v44, v74
    v_exp_f32 v45, v78
    v_exp_f32 v46, v82
    v_exp_f32 v47, v86
    v_exp_f32 v48, v75
    v_exp_f32 v49, v79
    v_exp_f32 v50, v83
    v_exp_f32 v51, v87
    v_pk_fma_f32 v[52:53], v[52:53], v[44:45], v[52:53]
    v_pk_fma_f32 v[54:55], v[54:55], v[46:47], v[54:55]
    v_pk_fma_f32 v[52:53], v[144:145], v[56:57], v[52:53]
    v_pk_fma_f32 v[54:55], v[146:147], v[58:59], v[54:55]
    v_pk_fma_f32 v[56:57], v[56:57], v[44:45], v[56:57]
    v_pk_fma_f32 v[58:59], v[58:59], v[46:47], v[58:59]
    v_pk_fma_f32 v[52:53], v[52:53], v[48:49], v[52:53]
    v_pk_fma_f32 v[54:55], v[54:55], v[50:51], v[54:55]
    v_pk_fma_f32 v[52:53], v[148:149], v[56:57], v[52:53]
    v_pk_fma_f32 v[54:55], v[150:151], v[58:59], v[54:55]
    v_pk_fma_f32 v[56:57], v[56:57], v[48:49], v[56:57]
    v_pk_fma_f32 v[58:59], v[58:59], v[50:51], v[58:59]
    s_branch L_mdone
L_T2:
    v_mfma_f32_32x32x8_bf16 v[88:103], v[16:17], v[32:33], 0
    v_exp_f32 v44, v72
    v_exp_f32 v45, v76
    v_exp_f32 v46, v80
    v_exp_f32 v47, v84
    v_mfma_f32_16x16x4_4b_bf16 v[88:103], v[30:31], v[18:19], v[88:103] cbsz:2 abid:3
    v_exp_f32 v48, v73
    v_exp_f32 v49, v77
    v_exp_f32 v50, v81
    v_exp_f32 v51, v85
    ds_read_b32 v3, v2 offset:1568
    v_pk_fma_f32 v[52:53], v[52:53], v[44:45], v[52:53]
    v_pk_fma_f32 v[54:55], v[54:55], v[46:47], v[54:55]
    ds_read_b64 v[60:61], v68 offset:20736
    v_pk_fma_f32 v[52:53], v[136:137], v[56:57], v[52:53]
    v_pk_fma_f32 v[54:55], v[138:139], v[58:59], v[54:55]
    ds_read_b64 v[62:63], v68 offset:20864
    v_pk_fma_f32 v[56:57], v[56:57], v[44:45], v[56:57]
    v_pk_fma_f32 v[58:59], v[58:59], v[46:47], v[58:59]
    ds_read_b64 v[64:65], v68 offset:20992
    v_pk_fma_f32 v[52:53], v[52:53], v[48:49], v[52:53]
    v_pk_fma_f32 v[54:55], v[54:55], v[50:51], v[54:55]
    ds_read_b64 v[66:67], v68 offset:21120
    v_pk_fma_f32 v[52:53], v[140:141], v[56:57], v[52:53]
    v_pk_fma_f32 v[54:55], v[142:143], v[58:59], v[54:55]
    v_pk_fma_f32 v[56:57], v[56:57], v[48:49], v[56:57]
    v_pk_fma_f32 v[58:59], v[58:59], v[50:51], v[58:59]
    s_waitcnt vmcnt(2)
    v_smfmac_f32_32x32x32_bf16 v[88:103], v[4:7], v[152:159], v12
    v_exp_f32 v44, v74
    v_exp_f32 v45, v78
    v_exp_f32 v46, v82
    v_exp_f32 v47, v86
    s_waitcnt vmcnt(0)
    v_smfmac_f32_32x32x32_bf16 v[88:103], v[8:11], v[160:167], v12
    v_exp_f32 v48, v75
    v_exp_f32 v49, v79
    v_exp_f32 v50, v83
    v_exp_f32 v51, v87
    v_pk_fma_f32 v[52:53], v[52:53], v[44:45], v[52:53]
    v_pk_fma_f32 v[54:55], v[54:55], v[46:47], v[54:55]
    v_pk_fma_f32 v[52:53], v[144:145], v[56:57], v[52:53]
    v_pk_fma_f32 v[54:55], v[146:147], v[58:59], v[54:55]
    v_pk_fma_f32 v[56:57], v[56:57], v[44:45], v[56:57]
    v_pk_fma_f32 v[58:59], v[58:59], v[46:47], v[58:59]
    v_pk_fma_f32 v[52:53], v[52:53], v[48:49], v[52:53]
    v_pk_fma_f32 v[54:55], v[54:55], v[50:51], v[54:55]
    v_pk_fma_f32 v[52:53], v[148:149], v[56:57], v[52:53]
    v_pk_fma_f32 v[54:55], v[150:151], v[58:59], v[54:55]
    v_pk_fma_f32 v[56:57], v[56:57], v[48:49], v[56:57]
    v_pk_fma_f32 v[58:59], v[58:59], v[50:51], v[58:59]
    v_exp_f32 v44, v88
    v_exp_f32 v45, v92
    v_exp_f32 v46, v96
    v_exp_f32 v47, v100
    v_exp_f32 v48, v89
    v_exp_f32 v49, v93
    v_exp_f32 v50, v97
    v_exp_f32 v51, v101
    v_pk_fma_f32 v[52:53], v[52:53], v[44:45], v[52:53]
    v_pk_fma_f32 v[54:55], v[54:55], v[46:47], v[54:55]
    v_pk_fma_f32 v[52:53], v[152:153], v[56:57], v[52:53]
    v_pk_fma_f32 v[54:55], v[154:155], v[58:59], v[54:55]
    v_pk_fma_f32 v[56:57], v[56:57], v[44:45], v[56:57]
    v_pk_fma_f32 v[58:59], v[58:59], v[46:47], v[58:59]
    v_pk_fma_f32 v[52:53], v[52:53], v[48:49], v[52:53]
    v_pk_fma_f32 v[54:55], v[54:55], v[50:51], v[54:55]
    v_pk_fma_f32 v[52:53], v[156:157], v[56:57], v[52:53]
    v_pk_fma_f32 v[54:55], v[158:159], v[58:59], v[54:55]
    v_pk_fma_f32 v[56:57], v[56:57], v[48:49], v[56:57]
    v_pk_fma_f32 v[58:59], v[58:59], v[50:51], v[58:59]
    v_exp_f32 v44, v90
    v_exp_f32 v45, v94
    v_exp_f32 v46, v98
    v_exp_f32 v47, v102
    v_exp_f32 v48, v91
    v_exp_f32 v49, v95
    v_exp_f32 v50, v99
    v_exp_f32 v51, v103
    v_pk_fma_f32 v[52:53], v[52:53], v[44:45], v[52:53]
    v_pk_fma_f32 v[54:55], v[54:55], v[46:47], v[54:55]
    v_pk_fma_f32 v[52:53], v[160:161], v[56:57], v[52:53]
    v_pk_fma_f32 v[54:55], v[162:163], v[58:59], v[54:55]
    v_pk_fma_f32 v[56:57], v[56:57], v[44:45], v[56:57]
    v_pk_fma_f32 v[58:59], v[58:59], v[46:47], v[58:59]
    v_pk_fma_f32 v[52:53], v[52:53], v[48:49], v[52:53]
    v_pk_fma_f32 v[54:55], v[54:55], v[50:51], v[54:55]
    v_pk_fma_f32 v[52:53], v[164:165], v[56:57], v[52:53]
    v_pk_fma_f32 v[54:55], v[166:167], v[58:59], v[54:55]
    v_pk_fma_f32 v[56:57], v[56:57], v[48:49], v[56:57]
    v_pk_fma_f32 v[58:59], v[58:59], v[50:51], v[58:59]
    s_branch L_mdone
L_T3:
    v_mfma_f32_32x32x8_bf16 v[72:87], v[16:17], v[32:33], 0
    v_exp_f32 v44, v88
    v_exp_f32 v45, v92
    v_exp_f32 v46, v96
    v_exp_f32 v47, v100
    v_mfma_f32_16x16x4_4b_bf16 v[72:87], v[30:31], v[18:19], v[72:87] cbsz:2 abid:0
    v_exp_f32 v48, v89
    v_exp_f32 v49, v93
    v_exp_f32 v50, v97
    v_exp_f32 v51, v101
    ds_read_b32 v3, v2 offset:1568
    v_pk_fma_f32 v[52:53], v[52:53], v[44:45], v[52:53]
    v_pk_fma_f32 v[54:55], v[54:55], v[46:47], v[54:55]
    ds_read_b64 v[60:61], v68 offset:20736
    v_pk_fma_f32 v[52:53], v[152:153], v[56:57], v[52:53]
    v_pk_fma_f32 v[54:55], v[154:155], v[58:59], v[54:55]
    ds_read_b64 v[62:63], v68 offset:20864
    v_pk_fma_f32 v[56:57], v[56:57], v[44:45], v[56:57]
    v_pk_fma_f32 v[58:59], v[58:59], v[46:47], v[58:59]
    ds_read_b64 v[64:65], v68 offset:20992
    v_pk_fma_f32 v[52:53], v[52:53], v[48:49], v[52:53]
    v_pk_fma_f32 v[54:55], v[54:55], v[50:51], v[54:55]
    ds_read_b64 v[66:67], v68 offset:21120
    v_pk_fma_f32 v[52:53], v[156:157], v[56:57], v[52:53]
    v_pk_fma_f32 v[54:55], v[158:159], v[58:59], v[54:55]
    v_pk_fma_f32 v[56:57], v[56:57], v[48:49], v[56:57]
    v_pk_fma_f32 v[58:59], v[58:59], v[50:51], v[58:59]
    s_waitcnt vmcnt(2)
    v_smfmac_f32_32x32x32_bf16 v[72:87], v[4:7], v[104:111], v12
    v_exp_f32 v44, v90
    v_exp_f32 v45, v94
    v_exp_f32 v46, v98
    v_exp_f32 v47, v102
    s_waitcnt vmcnt(0)
    v_smfmac_f32_32x32x32_bf16 v[72:87], v[8:11], v[112:119], v12
    v_exp_f32 v48, v91
    v_exp_f32 v49, v95
    v_exp_f32 v50, v99
    v_exp_f32 v51, v103
    v_pk_fma_f32 v[52:53], v[52:53], v[44:45], v[52:53]
    v_pk_fma_f32 v[54:55], v[54:55], v[46:47], v[54:55]
    v_pk_fma_f32 v[52:53], v[160:161], v[56:57], v[52:53]
    v_pk_fma_f32 v[54:55], v[162:163], v[58:59], v[54:55]
    v_pk_fma_f32 v[56:57], v[56:57], v[44:45], v[56:57]
    v_pk_fma_f32 v[58:59], v[58:59], v[46:47], v[58:59]
    v_pk_fma_f32 v[52:53], v[52:53], v[48:49], v[52:53]
    v_pk_fma_f32 v[54:55], v[54:55], v[50:51], v[54:55]
    v_pk_fma_f32 v[52:53], v[164:165], v[56:57], v[52:53]
    v_pk_fma_f32 v[54:55], v[166:167], v[58:59], v[54:55]
    v_pk_fma_f32 v[56:57], v[56:57], v[48:49], v[56:57]
    v_pk_fma_f32 v[58:59], v[58:59], v[50:51], v[58:59]
    v_exp_f32 v44, v72
    v_exp_f32 v45, v76
    v_exp_f32 v46, v80
    v_exp_f32 v47, v84
    v_exp_f32 v48, v73
    v_exp_f32 v49, v77
    v_exp_f32 v50, v81
    v_exp_f32 v51, v85
    v_pk_fma_f32 v[52:53], v[52:53], v[44:45], v[52:53]
    v_pk_fma_f32 v[54:55], v[54:55], v[46:47], v[54:55]
    v_pk_fma_f32 v[52:53], v[104:105], v[56:57], v[52:53]
    v_pk_fma_f32 v[54:55], v[106:107], v[58:59], v[54:55]
    v_pk_fma_f32 v[56:57], v[56:57], v[44:45], v[56:57]
    v_pk_fma_f32 v[58:59], v[58:59], v[46:47], v[58:59]
    v_pk_fma_f32 v[52:53], v[52:53], v[48:49], v[52:53]
    v_pk_fma_f32 v[54:55], v[54:55], v[50:51], v[54:55]
    v_pk_fma_f32 v[52:53], v[108:109], v[56:57], v[52:53]
    v_pk_fma_f32 v[54:55], v[110:111], v[58:59], v[54:55]
    v_pk_fma_f32 v[56:57], v[56:57], v[48:49], v[56:57]
    v_pk_fma_f32 v[58:59], v[58:59], v[50:51], v[58:59]
    v_exp_f32 v44, v74
    v_exp_f32 v45, v78
    v_exp_f32 v46, v82
    v_exp_f32 v47, v86
    v_exp_f32 v48, v75
    v_exp_f32 v49, v79
    v_exp_f32 v50, v83
    v_exp_f32 v51, v87
    v_pk_fma_f32 v[52:53], v[52:53], v[44:45], v[52:53]
    v_pk_fma_f32 v[54:55], v[54:55], v[46:47], v[54:55]
    v_pk_fma_f32 v[52:53], v[112:113], v[56:57], v[52:53]
    v_pk_fma_f32 v[54:55], v[114:115], v[58:59], v[54:55]
    v_pk_fma_f32 v[56:57], v[56:57], v[44:45], v[56:57]
    v_pk_fma_f32 v[58:59], v[58:59], v[46:47], v[58:59]
    v_pk_fma_f32 v[52:53], v[52:53], v[48:49], v[52:53]
    v_pk_fma_f32 v[54:55], v[54:55], v[50:51], v[54:55]
    v_pk_fma_f32 v[52:53], v[116:117], v[56:57], v[52:53]
    v_pk_fma_f32 v[54:55], v[118:119], v[58:59], v[54:55]
    v_pk_fma_f32 v[56:57], v[56:57], v[48:49], v[56:57]
    v_pk_fma_f32 v[58:59], v[58:59], v[50:51], v[58:59]
    s_branch L_mdone
L_dr:
    s_sub_u32 s31, s31, 1
    s_cbranch_scc1 L_dx
    ds_read_b32 v3, v2 offset:1568
    ds_read_b64 v[60:61], v68 offset:20736
    ds_read_b64 v[62:63], v68 offset:20864
    ds_read_b64 v[64:65], v68 offset:20992
    ds_read_b64 v[66:67], v68 offset:21120
    s_branch L_dw
L_safe:
    v_and_b32 v2, 15, v1
    v_lshlrev_b32 v3, 3, v2
    v_add_u32 v3, 161792, v3
    ds_read_u16 v80, v3 offset:0
    ds_read_u16 v81, v3 offset:2
    ds_read_u16 v82, v3 offset:4
    ds_read_u16 v83, v3 offset:6
    ds_read_u16 v84, v3 offset:128
    ds_read_u16 v85, v3 offset:130
    ds_read_u16 v86, v3 offset:132
    ds_read_u16 v87, v3 offset:134
    ds_read_u16 v88, v3 offset:256
    ds_read_u16 v89, v3 offset:258
    ds_read_u16 v90, v3 offset:260
    ds_read_u16 v91, v3 offset:262
    ds_read_u16 v92, v3 offset:384
    ds_read_u16 v93, v3 offset:386
    ds_read_u16 v94, v3 offset:388
    ds_read_u16 v95, v3 offset:390
    s_waitcnt lgkmcnt(0)
    v_lshlrev_b32 v80, 16, v80
    v_mul_f32 v80, s40, v80
    v_lshlrev_b32 v81, 16, v81
    v_mul_f32 v81, s40, v81
    v_lshlrev_b32 v82, 16, v82
    v_mul_f32 v82, s40, v82
    v_lshlrev_b32 v83, 16, v83
    v_mul_f32 v83, s40, v83
    v_lshlrev_b32 v84, 16, v84
    v_mul_f32 v84, s40, v84
    v_lshlrev_b32 v85, 16, v85
    v_mul_f32 v85, s40, v85
    v_lshlrev_b32 v86, 16, v86
    v_mul_f32 v86, s40, v86
    v_lshlrev_b32 v87, 16, v87
    v_mul_f32 v87, s40, v87
    v_lshlrev_b32 v88, 16, v88
    v_mul_f32 v88, s40, v88
    v_lshlrev_b32 v89, 16, v89
    v_mul_f32 v89, s40, v89
    v_lshlrev_b32 v90, 16, v90
    v_mul_f32 v90, s40, v90
    v_lshlrev_b32 v91, 16, v91
    v_mul_f32 v91, s40, v91
    v_lshlrev_b32 v92, 16, v92
    v_mul_f32 v92, s40, v92
    v_lshlrev_b32 v93, 16, v93
    v_mul_f32 v93, s40, v93
    v_lshlrev_b32 v94, 16, v94
    v_mul_f32 v94, s40, v94
    v_lshlrev_b32 v95, 16, v95
    v_mul_f32 v95, s40, v95
    v_lshrrev_b32 v24, 4, v1
    v_mul_u32_u24 v24, 3, v24
    s_movk_i32 s33, 648
    v_add_u32 v25, 75776, v20
    s_mov_b32 s34, s3
    s_mov_b32 s35, 200000
L_scell:
    s_lshl_b32 s30, s34, 10
    s_lshl_b32 s31, s23, 3
    s_add_u32 s30, s30, s31
    s_add_u32 s30, s30, 9437184
    v_mov_b32 v26, s30
    global_load_dword v32, v26, s[20:21] sc1
    s_mul_i32 s30, s34, 3968
    s_add_u32 s30, s30, 1310720
    s_waitcnt vmcnt(0)
    v_bfe_u32 v28, v32, 12, 12
    v_and_b32 v27, 0xfff, v32
    v_add_u32 v27, s30, v27
L_sver:
    v_mov_b32 v29, v1
    v_mov_b32 v31, 0
L_sv1:
    v_cmp_ge_u32 vcc, v28, v29
    s_and_saveexec_b64 s[48:49], vcc
    s_cbranch_execz L_sv2
    v_add_lshl_u32 v30, v27, v29, 2
    global_load_dword v32, v30, s[20:21] sc1
    s_waitcnt vmcnt(0)
    v_add_u32 v31, v31, v32
    s_mov_b64 exec, s[48:49]
    v_add_u32 v29, 64, v29
    s_branch L_sv1
L_sv2:
    s_mov_b64 exec, s[48:49]
    s_nop 1
    v_add_u32_dpp v31, v31, v31 row_shr:1 row_mask:0xf bank_mask:0xf bound_ctrl:0
    s_nop 1
    v_add_u32_dpp v31, v31, v31 row_shr:2 row_mask:0xf bank_mask:0xf bound_ctrl:0
    s_nop 1
    v_add_u32_dpp v31, v31, v31 row_shr:4 row_mask:0xf bank_mask:0xf bound_ctrl:0
    s_nop 1
    v_add_u32_dpp v31, v31, v31 row_shr:8 row_mask:0xf bank_mask:0xf bound_ctrl:0
    s_nop 1
    v_add_u32_dpp v31, v31, v31 row_bcast:15 row_mask:0xa bank_mask:0xf
    s_nop 1
    v_add_u32_dpp v31, v31, v31 row_bcast:31 row_mask:0xc bank_mask:0xf
    s_nop 0
    v_readlane_b32 s30, v31, 63
    s_cmp_eq_u32 s30, s27
    s_cbranch_scc1 L_sok
    s_sub_u32 s35, s35, 1
    s_cbranch_scc0 L_sver
    s_branch L_sdone
L_sok:
    v_mov_b32 v29, v24
L_srec:
    v_cmp_gt_u32 vcc, v28, v29
    s_and_saveexec_b64 s[48:49], vcc
    s_cbranch_execz L_snext
    v_add_lshl_u32 v30, v27, v29, 2
    global_load_dwordx3 v[32:34], v30, s[20:21] offset:4 sc1
    s_waitcnt vmcnt(0)
    v_and_b32 v30, 0x3fff00, v32
    v_add_u32 v30, v30, v14
    buffer_load_dwordx4 v[36:39], v30, s[36:39], 0 offen sc1
    v_lshrrev_b32 v31, 24, v32
    v_mad_u32_u24 v31, v31, s33, v25
    ds_read_b64 v[40:41], v31 offset:512
    v_lshlrev_b32 v44, 16, v33
    v_and_b32 v45, 0xffff0000, v33
    v_lshlrev_b32 v46, 16, v34
    v_and_b32 v47, 0xffff0000, v34
    s_waitcnt vmcnt(0) lgkmcnt(0)
    v_lshlrev_b32 v48, 16, v40
    v_and_b32 v49, 0xffff0000, v40
    v_lshlrev_b32 v50, 16, v41
    v_and_b32 v51, 0xffff0000, v41
    v_lshlrev_b32 v52, 16, v36
    v_add_f32 v48, v48, v52
    v_fmac_f32 v48, v44, v80
    v_fmac_f32 v48, v45, v84
    v_fmac_f32 v48, v46, v88
    v_fmac_f32 v48, v47, v92
    v_lshlrev_b32 v52, 16, v37
    v_add_f32 v49, v49, v52
    v_fmac_f32 v49, v44, v81
    v_fmac_f32 v49, v45, v85
    v_fmac_f32 v49, v46, v89
    v_fmac_f32 v49, v47, v93
    v_lshlrev_b32 v52, 16, v38
    v_add_f32 v50, v50, v52
    v_fmac_f32 v50, v44, v82
    v_fmac_f32 v50, v45, v86
    v_fmac_f32 v50, v46, v90
    v_fmac_f32 v50, v47, v94
    v_lshlrev_b32 v52, 16, v39
    v_add_f32 v51, v51, v52
    v_fmac_f32 v51, v44, v83
    v_fmac_f32 v51, v45, v87
    v_fmac_f32 v51, v46, v91
    v_fmac_f32 v51, v47, v95
    v_exp_f32 v48, v48
    v_exp_f32 v49, v49
    v_exp_f32 v50, v50
    v_exp_f32 v51, v51
    s_nop 0
    v_add_f32 v48, 1.0, v48
    v_add_f32 v49, 1.0, v49
    v_add_f32 v50, 1.0, v50
    v_add_f32 v51, 1.0, v51
    v_rcp_f32 v48, v48
    v_rcp_f32 v49, v49
    v_rcp_f32 v50, v50
    v_rcp_f32 v51, v51
    s_nop 0
    v_mul_f32 v48, v48, v36
    v_mul_f32 v49, v49, v37
    v_mul_f32 v50, v50, v38
    v_mul_f32 v51, v51, v39
    v_cvt_f64_f32 v[54:55], v48
    v_cvt_f64_f32 v[56:57], v49
    v_cvt_f64_f32 v[58:59], v50
    v_cvt_f64_f32 v[60:61], v51
    ds_add_f64 v31, v[54:55] offset:0
    ds_add_f64 v31, v[56:57] offset:128
    ds_add_f64 v31, v[58:59] offset:256
    ds_add_f64 v31, v[60:61] offset:384
    s_mov_b64 exec, s[48:49]
    v_add_u32 v29, 12, v29
    s_branch L_srec
L_snext:
    s_mov_b64 exec, s[48:49]
    s_add_u32 s34, s34, 12
    s_cmp_lt_u32 s34, 250
    s_cbranch_scc1 L_scell
L_sdone:
    s_waitcnt lgkmcnt(0)
    s_barrier
    v_mov_b32 v3, 0
    v_mov_b32 v52, 0
    v_mov_b32 v56, 1.0
    ds_read_b64 v[60:61], v68 offset:20736
    v_mov_b32 v53, 0
    v_mov_b32 v57, 1.0
    ds_read_b64 v[62:63], v68 offset:20864
    v_mov_b32 v54, 0
    v_mov_b32 v58, 1.0
    ds_read_b64 v[64:65], v68 offset:20992
    v_mov_b32 v55, 0
    v_mov_b32 v59, 1.0
    ds_read_b64 v[66:67], v68 offset:21120
    s_branch L_mdone
L_codeend:
.section .rodata,"a"
.p2align 6
.amdhsa_kernel standalone__edge_featured_mpnn_egc__graph_kernel
.amdhsa_next_free_vgpr 168
.amdhsa_next_free_sgpr 102
.amdhsa_accum_offset 168
.amdhsa_group_segment_fixed_size 0
.amdhsa_kernarg_size 80
.amdhsa_user_sgpr_count 2
.amdhsa_user_sgpr_kernarg_segment_ptr 1
.amdhsa_system_sgpr_workgroup_id_x 1
.end_amdhsa_kernel
```
